```python
import torch

def _softmax(x, axis=-1):
    return torch.softmax(x, dim=axis)
def _gelu(x):
    return torch.nn.functional.gelu(x, approximate="tanh")
def _silu(x):
    return torch.nn.functional.silu(x)
def _sigmoid(x):
    return torch.sigmoid(x)
def _layernorm(x, axis=-1, eps=1e-5):
    m = x.mean(dim=axis, keepdim=True)
    v = x.var(dim=axis, keepdim=True, unbiased=False)
    return (x - m) / torch.sqrt(v + eps)
def _scatter_add(tgt, idx, src, axis=0):
    return tgt.clone().index_add_(axis, idx, src)
def _segment_sum(src, seg, n):
    out = torch.zeros((n,) + src.shape[1:], dtype=src.dtype)
    return out.index_add_(0, seg, src)
def _pad(x, pw):
    flat = tuple(v for pair in reversed(pw) for v in pair)
    return torch.nn.functional.pad(x, flat)

kernel_name = 'concat_heads__softmax_full_mha__ssm_conv_s4d__prompt'

def setup_inputs():

    _w = (lambda a: (lambda t: t.to(torch.bfloat16) if t.is_floating_point() else t)(torch.as_tensor(a)))
    def _A_setup():
        B, S, D = 1, 2048, 512
        return {
            "x": _w((lambda *s: torch.randn(*s, dtype=torch.bfloat16) * 0.2)(B, S, D)),
            "wqkv": _w((lambda *s: torch.randn(*s, dtype=torch.bfloat16) * 0.2)(D, 3 * D)),
            "wo": _w((lambda *s: torch.randn(*s, dtype=torch.bfloat16) * 0.05)(D, D)),
        }
    _A_in = _A_setup()

    def _B_setup():
        Bsz, L, D, N = 1, 2048, 512, 128
        return {
            "u": _w((lambda *s: torch.randn(*s, dtype=torch.bfloat16) * 0.05)(Bsz, L, D)),
            "log_A_real": _w((lambda *s: torch.randn(*s, dtype=torch.bfloat16) * 6.4)(D, N) * 0.5),
            "A_imag": _w((lambda *s: torch.randn(*s, dtype=torch.bfloat16) * 0.05)(D, N) * 3.14),
            "C_real": _w((lambda *s: torch.randn(*s, dtype=torch.bfloat16) * 0.4)(D, N) / N ** 0.5),
            "C_imag": _w((lambda *s: torch.randn(*s, dtype=torch.bfloat16) * 0.4)(D, N) / N ** 0.5),
            "log_dt": _w((lambda *s: torch.randn(*s, dtype=torch.bfloat16) * 0.05)(D) * 0.5 - 4.0),
            "D_skip": _w((lambda *s: torch.randn(*s, dtype=torch.bfloat16) * 0.05)(D)),
        }
    _B_in = _B_setup()

    return {
        "A_x": _A_in["x"],
        "A_wqkv": _A_in["wqkv"],
        "A_wo": _A_in["wo"],
        "B_u": _B_in["u"],
        "B_log_A_real": _B_in["log_A_real"],
        "B_A_imag": _B_in["A_imag"],
        "B_C_real": _B_in["C_real"],
        "B_C_imag": _B_in["C_imag"],
        "B_log_dt": _B_in["log_dt"],
        "B_D_skip": _B_in["D_skip"],
    }

def reference(A_x, A_wqkv, A_wo, B_u, B_log_A_real, B_A_imag, B_C_real, B_C_imag, B_log_dt, B_D_skip):
    def _A_ref(x, wqkv, wo):
        B, S, D = x.shape
        H = 32; Dh = D // H
        qkv = (lambda x, *d: x.permute(*d))((x @ wqkv).reshape(B, S, 3, H, Dh), 2, 0, 3, 1, 4)
        q, k, v = qkv[0], qkv[1], qkv[2]
        scale = Dh ** -0.5
        scores = torch.einsum("bhqd,bhkd->bhqk", q, k) * scale
        p = _softmax(scores, axis=-1)
        o = torch.einsum("bhqk,bhkd->bhqd", p, v)
        return (lambda x, *d: x.permute(*d))(o, 0, 2, 1, 3).reshape(B, S, D) @ wo

    def _B_ref(u, log_A_real, A_imag, C_real, C_imag, log_dt, D_skip):
        L = u.shape[1]
        dt = torch.exp(log_dt)
        A = -torch.exp(log_A_real) + 1j * A_imag
        C = (C_real + 1j * C_imag) * dt[:, None]
        pos = (lambda x, dt: x.to(dt))(torch.arange(L), log_dt.dtype)
        P = torch.exp((A * dt[:, None])[:, :, None] * pos[None, None, :])
        K = 2.0 * torch.einsum("dn,dnl->dl", C, P).real
        L2 = 2 * L
        u_t = (lambda x, *d: x.permute(*d))(u, 0, 2, 1)
        Kf = (lambda x, *a, **k: torch.fft.rfft(x.float(), *a, **k))(K, L2)
        Uf = (lambda x, *a, **k: torch.fft.rfft(x.float(), *a, **k))(u_t, L2)
        y = (lambda x, *a, **k: torch.fft.irfft(x, *a, **k).to(torch.bfloat16))(Uf * Kf[None, :, :], L2)[:, :, :L]
        y = (lambda x, *d: x.permute(*d))(y, 0, 2, 1)
        return y + u * D_skip[None, None, :]

    a = _A_ref(A_x, A_wqkv, A_wo)
    b = _B_ref(B_u, B_log_A_real, B_A_imag, B_C_real, B_C_imag, B_log_dt, B_D_skip)
    return torch.concatenate([a, b], axis=-1)
```

```asm
; @launch grid=(256,1,1) block=(1024,1,1) lds=163840
.amdgcn_target "amdgcn-amd-amdhsa--gfx950"
.text
.globl concat_heads__softmax_full_mha__ssm_conv_s4d__prompt_kernel
.p2align 8
.type concat_heads__softmax_full_mha__ssm_conv_s4d__prompt_kernel,@function
concat_heads__softmax_full_mha__ssm_conv_s4d__prompt_kernel:
  s_cmp_ge_u32 s2, 256
  s_cbranch_scc1 L_exit
  s_load_dwordx16 s[8:23], s[0:1], 0
  s_load_dwordx8 s[24:31], s[0:1], 64
  s_load_dwordx2 s[32:33], s[0:1], 96
  s_getpc_b64 s[70:71]
L_pc:
  v_lshrrev_b32 v2, 6, v0
  v_and_b32 v1, 63, v0
  s_lshr_b32 s61, s2, 3
  s_lshl_b32 s72, s61, 10
  v_lshl_add_u32 v3, v0, 7, s72
  v_min_u32 v3, L_code_end-L_pc-4, v3
  v_cmp_gt_u32 vcc, 8, v0
  s_and_saveexec_b64 s[74:75], vcc
  s_cbranch_execz L_nocodepf
  global_load_dword v9, v3, s[70:71]
L_nocodepf:
  s_mov_b64 exec, -1
  s_and_b32 s60, s2, 7
  v_readfirstlane_b32 s65, v2
  s_lshr_b32 s62, s61, 2
  s_and_b32 s63, s61, 3
  s_lshl_b32 s64, s63, 1
  s_add_u32 s64, s64, s62
  s_sub_u32 s70, s65, 4
  s_cmp_lt_u32 s70, 6
  s_cbranch_scc0 L_notloader
  s_setprio 2
  v_lshrrev_b32 v4, 3, v1
  v_and_b32 v5, 7, v1
  v_lshrrev_b32 v6, 1, v4
  v_xor_b32 v7, v5, v6
  v_lshlrev_b32 v7, 4, v7
  v_lshl_add_u32 v10, v4, 10, v7
  v_xor_b32 v11, 64, v10
  v_bfe_u32 v4, v1, 2, 3
  v_mul_u32_u24 v4, 3072, v4
  v_lshrrev_b32 v5, 5, v1
  v_lshl_add_u32 v4, v5, 6, v4
  v_and_b32 v5, 3, v1
  v_lshl_add_u32 v12, v5, 4, v4
  s_and_b32 s71, s70, 1
  s_lshr_b32 s82, s70, 1
  s_lshl_b32 s5, s82, 15
  s_lshl_b32 s72, s71, 12
  s_add_u32 s5, s5, s72
  s_lshl_b32 s3, s60, 18
  s_lshl_b32 s72, s63, 16
  s_add_u32 s3, s3, s72
  s_lshl_b32 s72, s71, 15
  s_add_u32 s3, s3, s72
  s_mul_i32 s4, s71, 98304
  s_lshl_b32 s72, s62, 7
  s_add_u32 s4, s4, s72
  s_lshl_b32 s71, s71, 2
  s_add_u32 s72, s71, 163536
  v_mov_b32 v13, s72
  s_lshl_b32 s72, s82, 3
  s_add_u32 s72, s72, s71
  s_add_u32 s72, s72, 163616
  v_mov_b32 v17, s72
  s_waitcnt lgkmcnt(0)
  s_mov_b32 s36, s8
  s_mov_b32 s37, s9
  s_mov_b32 s38, 2097152
  s_mov_b32 s39, 0x20000
  s_mov_b32 s40, s10
  s_mov_b32 s41, s11
  s_mov_b32 s42, 1572864
  s_mov_b32 s43, 0x20000
  s_cmp_eq_u32 s82, 0
  s_cbranch_scc1 L_ld_first
  s_load_dword s66, s[32:33], 0
  s_getreg_b32 s69, hwreg(HW_REG_XCC_ID)
  s_mov_b32 s44, s32
  s_mov_b32 s45, s33
  s_mov_b32 s46, 25165824
  s_mov_b32 s47, 0x20000
  s_mov_b32 s48, s14
  s_mov_b32 s49, s15
  s_mov_b32 s50, 2097152
  s_mov_b32 s51, 0x20000
  s_mov_b32 s52, s12
  s_mov_b32 s53, s13
  s_mov_b32 s54, 524288
  s_mov_b32 s55, 0x20000
  s_mov_b32 s56, s28
  s_mov_b32 s57, s29
  s_mov_b32 s58, 4194304
  s_mov_b32 s59, 0x20000
  s_mov_b32 s68, s61
  s_and_b32 s69, s69, 15
  s_lshl_b32 s86, s2, 11
  s_add_u32 s86, s86, 1048576
  s_mov_b32 s78, 0x0000ffff
  s_mov_b32 s79, 0x0000ffff
  s_waitcnt lgkmcnt(0)
  s_mul_i32 s66, s66, 0x9e3779b1
  s_add_u32 s66, s66, 0x7f4a7c15
  s_lshl_b32 s72, s82, 3
  s_add_u32 s72, s72, 163608
  v_mov_b32 v14, s72
  s_mov_b32 s84, 0
L_lspin_1:
  ds_read_b64 v[20:21], v14 offset:0
  s_add_u32 s84, s84, 1
  s_waitcnt lgkmcnt(0)
  v_cmp_ne_u32 vcc, s66, v20
  v_cmp_ne_u32 s[6:7], s66, v21
  s_nop 0
  s_or_b64 vcc, vcc, s[6:7]
  s_cbranch_vccz L_lspin_1_x
  s_cmp_gt_u32 s84, 400000
  s_cbranch_scc0 L_lspin_1
L_lspin_1_x:
  s_cmp_eq_u32 s82, 2
  s_cbranch_scc0 L_ld_go
  v_mov_b32 v14, 163424
  s_mov_b32 s84, 0
L_lspin_2:
  ds_read_b32 v20, v14 offset:0
  s_add_u32 s84, s84, 1
  s_waitcnt lgkmcnt(0)
  v_cmp_ne_u32 vcc, s66, v20
  s_cbranch_vccz L_lspin_2_x
  s_sleep 1
  s_cmp_gt_u32 s84, 400000
  s_cbranch_scc0 L_lspin_2
L_lspin_2_x:
L_ld_go:
  s_add_u32 s72, s64, s82
  s_and_b32 s72, s72, 7
  s_lshl_b32 s70, s72, 7
  s_add_u32 s70, s70, s3
  s_mul_i32 s74, s72, 196608
  s_add_u32 s74, s74, s4
  s_add_u32 m0, s5, 0
  s_add_u32 s71, s70, 0
  buffer_load_dwordx4 v10, s[36:39], s71 offen lds
  s_add_u32 m0, s5, 8192
  s_add_u32 s71, s74, 0
  buffer_load_dwordx4 v12, s[40:43], s71 offen lds
  s_add_u32 m0, s5, 16384
  s_add_u32 s71, s74, 1024
  buffer_load_dwordx4 v12, s[40:43], s71 offen lds
  s_add_u32 m0, s5, 24576
  s_add_u32 s71, s74, 2048
  buffer_load_dwordx4 v12, s[40:43], s71 offen lds
  s_add_u32 m0, s5, 1024
  s_add_u32 s71, s70, 8192
  buffer_load_dwordx4 v11, s[36:39], s71 offen lds
  s_add_u32 m0, s5, 9216
  s_add_u32 s71, s74, 24576
  buffer_load_dwordx4 v12, s[40:43], s71 offen lds
  s_add_u32 m0, s5, 17408
  s_add_u32 s71, s74, 25600
  buffer_load_dwordx4 v12, s[40:43], s71 offen lds
  s_add_u32 m0, s5, 25600
  s_add_u32 s71, s74, 26624
  buffer_load_dwordx4 v12, s[40:43], s71 offen lds
  s_add_u32 m0, s5, 2048
  s_add_u32 s71, s70, 16384
  buffer_load_dwordx4 v10, s[36:39], s71 offen lds
  s_add_u32 m0, s5, 10240
  s_add_u32 s71, s74, 49152
  buffer_load_dwordx4 v12, s[40:43], s71 offen lds
  s_add_u32 m0, s5, 18432
  s_add_u32 s71, s74, 50176
  buffer_load_dwordx4 v12, s[40:43], s71 offen lds
  s_add_u32 m0, s5, 26624
  s_add_u32 s71, s74, 51200
  buffer_load_dwordx4 v12, s[40:43], s71 offen lds
  s_add_u32 m0, s5, 3072
  s_add_u32 s71, s70, 24576
  buffer_load_dwordx4 v11, s[36:39], s71 offen lds
  s_add_u32 m0, s5, 11264
  s_add_u32 s71, s74, 73728
  buffer_load_dwordx4 v12, s[40:43], s71 offen lds
  s_add_u32 m0, s5, 19456
  s_add_u32 s71, s74, 74752
  buffer_load_dwordx4 v12, s[40:43], s71 offen lds
  s_add_u32 m0, s5, 27648
  s_add_u32 s71, s74, 75776
  buffer_load_dwordx4 v12, s[40:43], s71 offen lds
  s_branch L_ld_issued
L_ld_first:
  s_add_u32 s72, s64, s82
  s_and_b32 s72, s72, 7
  s_lshl_b32 s70, s72, 7
  s_add_u32 s70, s70, s3
  s_mul_i32 s74, s72, 196608
  s_add_u32 s74, s74, s4
  s_add_u32 m0, s5, 0
  s_add_u32 s71, s70, 0
  buffer_load_dwordx4 v10, s[36:39], s71 offen lds
  s_add_u32 m0, s5, 8192
  s_add_u32 s71, s74, 0
  buffer_load_dwordx4 v12, s[40:43], s71 offen lds
  s_add_u32 m0, s5, 16384
  s_add_u32 s71, s74, 1024
  buffer_load_dwordx4 v12, s[40:43], s71 offen lds
  s_add_u32 m0, s5, 24576
  s_add_u32 s71, s74, 2048
  buffer_load_dwordx4 v12, s[40:43], s71 offen lds
  s_add_u32 m0, s5, 1024
  s_add_u32 s71, s70, 8192
  buffer_load_dwordx4 v11, s[36:39], s71 offen lds
  s_add_u32 m0, s5, 9216
  s_add_u32 s71, s74, 24576
  buffer_load_dwordx4 v12, s[40:43], s71 offen lds
  s_add_u32 m0, s5, 17408
  s_add_u32 s71, s74, 25600
  buffer_load_dwordx4 v12, s[40:43], s71 offen lds
  s_add_u32 m0, s5, 25600
  s_add_u32 s71, s74, 26624
  buffer_load_dwordx4 v12, s[40:43], s71 offen lds
  s_add_u32 m0, s5, 2048
  s_add_u32 s71, s70, 16384
  buffer_load_dwordx4 v10, s[36:39], s71 offen lds
  s_add_u32 m0, s5, 10240
  s_add_u32 s71, s74, 49152
  buffer_load_dwordx4 v12, s[40:43], s71 offen lds
  s_add_u32 m0, s5, 18432
  s_add_u32 s71, s74, 50176
  buffer_load_dwordx4 v12, s[40:43], s71 offen lds
  s_add_u32 m0, s5, 26624
  s_add_u32 s71, s74, 51200
  buffer_load_dwordx4 v12, s[40:43], s71 offen lds
  s_add_u32 m0, s5, 3072
  s_add_u32 s71, s70, 24576
  buffer_load_dwordx4 v11, s[36:39], s71 offen lds
  s_add_u32 m0, s5, 11264
  s_add_u32 s71, s74, 73728
  buffer_load_dwordx4 v12, s[40:43], s71 offen lds
  s_add_u32 m0, s5, 19456
  s_add_u32 s71, s74, 74752
  buffer_load_dwordx4 v12, s[40:43], s71 offen lds
  s_add_u32 m0, s5, 27648
  s_add_u32 s71, s74, 75776
  buffer_load_dwordx4 v12, s[40:43], s71 offen lds
  s_load_dword s66, s[32:33], 0
  s_getreg_b32 s69, hwreg(HW_REG_XCC_ID)
  s_mov_b32 s44, s32
  s_mov_b32 s45, s33
  s_mov_b32 s46, 25165824
  s_mov_b32 s47, 0x20000
  s_mov_b32 s48, s14
  s_mov_b32 s49, s15
  s_mov_b32 s50, 2097152
  s_mov_b32 s51, 0x20000
  s_mov_b32 s52, s12
  s_mov_b32 s53, s13
  s_mov_b32 s54, 524288
  s_mov_b32 s55, 0x20000
  s_mov_b32 s56, s28
  s_mov_b32 s57, s29
  s_mov_b32 s58, 4194304
  s_mov_b32 s59, 0x20000
  s_mov_b32 s68, s61
  s_and_b32 s69, s69, 15
  s_lshl_b32 s86, s2, 11
  s_add_u32 s86, s86, 1048576
  s_mov_b32 s78, 0x0000ffff
  s_mov_b32 s79, 0x0000ffff
  s_waitcnt lgkmcnt(0)
  s_mul_i32 s66, s66, 0x9e3779b1
  s_add_u32 s66, s66, 0x7f4a7c15
L_ld_issued:
  v_mov_b32 v15, s66
  ds_write_b32 v17, v15
  v_mov_b32 v14, 163664
L_ld_loop:
  s_lshl_b32 s70, s82, 3
  v_add_u32 v18, s70, v13
  s_waitcnt vmcnt(0)
  ds_write_b32 v18, v15
  s_add_u32 s82, s82, 3
  s_cmp_ge_u32 s82, 8
  s_cbranch_scc1 L_ld_done
  s_lshl_b32 s70, s82, 4
  s_add_u32 s70, s70, 163616
  v_mov_b32 v14, s70
  s_mov_b32 s84, 0
L_lspin_3:
  ds_read_b128 v[20:23], v14 offset:0
  s_add_u32 s84, s84, 1
  s_waitcnt lgkmcnt(0)
  v_cmp_ne_u32 vcc, s66, v20
  v_cmp_ne_u32 s[6:7], s66, v21
  s_nop 0
  s_or_b64 vcc, vcc, s[6:7]
  v_cmp_ne_u32 s[6:7], s66, v22
  s_nop 0
  s_or_b64 vcc, vcc, s[6:7]
  v_cmp_ne_u32 s[6:7], s66, v23
  s_nop 0
  s_or_b64 vcc, vcc, s[6:7]
  s_cbranch_vccz L_lspin_3_x
  s_sleep 1
  s_cmp_gt_u32 s84, 400000
  s_cbranch_scc0 L_lspin_3
L_lspin_3_x:
  s_add_u32 s72, s64, s82
  s_and_b32 s72, s72, 7
  s_lshl_b32 s70, s72, 7
  s_add_u32 s70, s70, s3
  s_mul_i32 s74, s72, 196608
  s_add_u32 s74, s74, s4
  s_add_u32 m0, s5, 0
  s_add_u32 s71, s70, 0
  buffer_load_dwordx4 v10, s[36:39], s71 offen lds
  s_add_u32 m0, s5, 8192
  s_add_u32 s71, s74, 0
  buffer_load_dwordx4 v12, s[40:43], s71 offen lds
  s_add_u32 m0, s5, 16384
  s_add_u32 s71, s74, 1024
  buffer_load_dwordx4 v12, s[40:43], s71 offen lds
  s_add_u32 m0, s5, 24576
  s_add_u32 s71, s74, 2048
  buffer_load_dwordx4 v12, s[40:43], s71 offen lds
  s_add_u32 m0, s5, 1024
  s_add_u32 s71, s70, 8192
  buffer_load_dwordx4 v11, s[36:39], s71 offen lds
  s_add_u32 m0, s5, 9216
  s_add_u32 s71, s74, 24576
  buffer_load_dwordx4 v12, s[40:43], s71 offen lds
  s_add_u32 m0, s5, 17408
  s_add_u32 s71, s74, 25600
  buffer_load_dwordx4 v12, s[40:43], s71 offen lds
  s_add_u32 m0, s5, 25600
  s_add_u32 s71, s74, 26624
  buffer_load_dwordx4 v12, s[40:43], s71 offen lds
  s_add_u32 m0, s5, 2048
  s_add_u32 s71, s70, 16384
  buffer_load_dwordx4 v10, s[36:39], s71 offen lds
  s_add_u32 m0, s5, 10240
  s_add_u32 s71, s74, 49152
  buffer_load_dwordx4 v12, s[40:43], s71 offen lds
  s_add_u32 m0, s5, 18432
  s_add_u32 s71, s74, 50176
  buffer_load_dwordx4 v12, s[40:43], s71 offen lds
  s_add_u32 m0, s5, 26624
  s_add_u32 s71, s74, 51200
  buffer_load_dwordx4 v12, s[40:43], s71 offen lds
  s_add_u32 m0, s5, 3072
  s_add_u32 s71, s70, 24576
  buffer_load_dwordx4 v11, s[36:39], s71 offen lds
  s_add_u32 m0, s5, 11264
  s_add_u32 s71, s74, 73728
  buffer_load_dwordx4 v12, s[40:43], s71 offen lds
  s_add_u32 m0, s5, 19456
  s_add_u32 s71, s74, 74752
  buffer_load_dwordx4 v12, s[40:43], s71 offen lds
  s_add_u32 m0, s5, 27648
  s_add_u32 s71, s74, 75776
  buffer_load_dwordx4 v12, s[40:43], s71 offen lds
  s_cmp_eq_u32 s82, 7
  s_cbranch_scc0 L_ld_loop
  v_mov_b32 v14, 163520
  ds_read_b64 v[20:21], v14
  v_lshrrev_b32 v22, 4, v1
  v_lshlrev_b32 v22, 16, v22
  v_and_b32 v23, 15, v1
  v_lshl_add_u32 v22, v23, 7, v22
  s_lshl_b32 s70, s62, 18
  s_lshl_b32 s71, s60, 13
  s_add_u32 s70, s70, s71
  s_lshl_b32 s71, s63, 11
  s_add_u32 s70, s70, s71
  s_waitcnt lgkmcnt(0)
  v_readfirstlane_b32 s71, v20
  v_readfirstlane_b32 s72, v21
  s_cmp_eq_u32 s72, s66
  s_cbranch_scc0 L_ld_loop
  s_cmp_eq_u32 s71, 1
  s_cbranch_scc0 L_ld_loop
  s_lshl_b32 s72, s82, 3
  v_add_u32 v18, s72, v13
  s_cmp_eq_u32 s65, 6
  s_cbranch_scc0 L_ld_touchv
  s_add_u32 s71, s70, 10485760
  buffer_load_dword v24, v22, s[44:47], s71 offen
  s_add_u32 s71, s70, 8388608
  buffer_load_dword v25, v22, s[44:47], s71 offen
  s_waitcnt vmcnt(2)
  s_branch L_ld_touched
L_ld_touchv:
  s_add_u32 s71, s70, 12582912
  buffer_load_dword v24, v22, s[44:47], s71 offen
  s_waitcnt vmcnt(1)
L_ld_touched:
  ds_write_b32 v18, v15
  s_branch L_ld_done
  s_branch L_ld_loop
L_ld_done:
  s_cmp_ge_u32 s65, 8
  s_cbranch_scc1 L_gap1_join
  s_lshl_b32 s5, s60, 1
  s_lshl_b32 s70, s68, 16
  s_and_b32 s4, s65, 3
  s_lshl_b32 s4, s4, 10
  s_add_u32 s35, s70, s4
  v_lshlrev_b32 v4, 4, v1
  v_lshlrev_b32 v2, 2, v1
  s_add_u32 s70, s86, 768
  v_add_u32 v2, s70, v2
  s_mov_b32 s84, 0
  s_mov_b64 exec, 0xff
  buffer_load_dword v3, v2, s[44:47], 0 offen sc1
L_loc_4:
  s_waitcnt vmcnt(0)
  v_cmp_ne_u32 vcc, s66, v3
  s_add_u32 s84, s84, 1
  s_nop 0
  s_and_b64 vcc, vcc, exec
  s_cbranch_scc0 L_loc_ok_5
  s_cmp_gt_u32 s84, 400000
  s_cbranch_scc1 L_loc_ok_5
  buffer_load_dword v3, v2, s[44:47], 0 offen sc1
  s_branch L_loc_4
L_loc_ok_5:
  s_mov_b64 exec, -1
  s_add_u32 s70, s5, 0
  s_and_b32 s70, s70, 15
  s_lshl_b32 s70, s70, 12
  s_add_u32 s70, s70, s35
  s_add_u32 m0, s4, 0
  s_add_u32 s74, s70, 10485760
  buffer_load_dwordx4 v4, s[44:47], s74 offen sc1 lds
  s_add_u32 m0, s4, 65536
  s_add_u32 s74, s70, 12582912
  buffer_load_dwordx4 v4, s[44:47], s74 offen sc1 lds
  s_add_u32 s70, s5, 1
  s_and_b32 s70, s70, 15
  s_lshl_b32 s70, s70, 12
  s_add_u32 s70, s70, s35
  s_add_u32 m0, s4, 4096
  s_add_u32 s74, s70, 10485760
  buffer_load_dwordx4 v4, s[44:47], s74 offen sc1 lds
  s_add_u32 m0, s4, 69632
  s_add_u32 s74, s70, 12582912
  buffer_load_dwordx4 v4, s[44:47], s74 offen sc1 lds
  s_lshl_b32 s70, s68, 16
  s_lshl_b32 s71, s60, 13
  s_add_u32 s70, s70, s71
  s_lshl_b32 s71, s4, 1
  s_add_u32 s70, s70, s71
  s_add_u32 s70, s70, 8388608
  s_add_u32 m0, s71, 73728
  s_add_u32 s74, s70, 0
  buffer_load_dwordx4 v4, s[44:47], s74 offen sc1 lds
  s_add_u32 m0, s71, 74752
  s_add_u32 s74, s70, 1024
  buffer_load_dwordx4 v4, s[44:47], s74 offen sc1 lds
  s_and_b32 s70, s65, 3
  s_lshl_b32 s70, s70, 2
  s_add_u32 s70, s70, 163472
  v_mov_b32 v2, s70
  v_mov_b32 v3, s66
  ds_write_b32 v2, v3
  v_lshlrev_b32 v5, 2, v1
  s_add_u32 s70, s86, 0
  v_add_u32 v5, s70, v5
  buffer_load_dword v6, v5, s[44:47], 0 offen sc1
  s_waitcnt vmcnt(1)
  s_branch L_gap1_join
L_notloader:
  s_waitcnt lgkmcnt(0)
  s_load_dword s66, s[32:33], 0
  s_getreg_b32 s69, hwreg(HW_REG_XCC_ID)
  s_mov_b32 s44, s32
  s_mov_b32 s45, s33
  s_mov_b32 s46, 25165824
  s_mov_b32 s47, 0x20000
  s_mov_b32 s48, s14
  s_mov_b32 s49, s15
  s_mov_b32 s50, 2097152
  s_mov_b32 s51, 0x20000
  s_mov_b32 s52, s12
  s_mov_b32 s53, s13
  s_mov_b32 s54, 524288
  s_mov_b32 s55, 0x20000
  s_mov_b32 s56, s28
  s_mov_b32 s57, s29
  s_mov_b32 s58, 4194304
  s_mov_b32 s59, 0x20000
  s_mov_b32 s68, s61
  s_and_b32 s69, s69, 15
  s_lshl_b32 s86, s2, 11
  s_add_u32 s86, s86, 1048576
  s_mov_b32 s78, 0x0000ffff
  s_mov_b32 s79, 0x0000ffff
  s_cmp_ge_u32 s65, 14
  s_cbranch_scc1 L_side
  s_cmp_ge_u32 s65, 10
  s_cbranch_scc1 L_kgen
L_gemm:
  s_setprio 3
  v_and_b32 v2, 31, v1
  v_lshrrev_b32 v3, 5, v1
  v_bfe_u32 v4, v2, 1, 3
  v_xor_b32 v4, v4, v3
  v_lshlrev_b32 v4, 4, v4
  s_and_b32 s70, s65, 1
  s_lshl_b32 s70, s70, 12
  v_lshl_add_u32 v4, v2, 7, v4
  v_add_u32 v10, s70, v4
  v_xor_b32 v11, 32, v10
  v_xor_b32 v12, 64, v10
  v_xor_b32 v13, 96, v10
  v_bfe_u32 v4, v1, 2, 2
  v_lshlrev_b32 v4, 6, v4
  v_lshl_add_u32 v4, v3, 10, v4
  v_bfe_u32 v5, v1, 4, 1
  v_lshl_add_u32 v4, v5, 5, v4
  v_and_b32 v5, 3, v1
  v_lshl_add_u32 v4, v5, 3, v4
  s_lshr_b32 s70, s65, 1
  s_lshl_b32 s70, s70, 9
  s_add_u32 s70, s70, 8192
  v_add_u32 v14, s70, v4
  v_mov_b32 v16, 0
  v_mov_b32 v17, 0
  v_mov_b32 v18, 0
  v_mov_b32 v19, 0
  v_mov_b32 v20, 0
  v_mov_b32 v21, 0
  v_mov_b32 v22, 0
  v_mov_b32 v23, 0
  v_mov_b32 v24, 0
  v_mov_b32 v25, 0
  v_mov_b32 v26, 0
  v_mov_b32 v27, 0
  v_mov_b32 v28, 0
  v_mov_b32 v29, 0
  v_mov_b32 v30, 0
  v_mov_b32 v31, 0
  v_mov_b32 v32, 0
  v_mov_b32 v33, 0
  v_mov_b32 v34, 0
  v_mov_b32 v35, 0
  v_mov_b32 v36, 0
  v_mov_b32 v37, 0
  v_mov_b32 v38, 0
  v_mov_b32 v39, 0
  v_mov_b32 v40, 0
  v_mov_b32 v41, 0
  v_mov_b32 v42, 0
  v_mov_b32 v43, 0
  v_mov_b32 v44, 0
  v_mov_b32 v45, 0
  v_mov_b32 v46, 0
  v_mov_b32 v47, 0
  v_mov_b32 v48, 0
  v_mov_b32 v49, 0
  v_mov_b32 v50, 0
  v_mov_b32 v51, 0
  v_mov_b32 v52, 0
  v_mov_b32 v53, 0
  v_mov_b32 v54, 0
  v_mov_b32 v55, 0
  v_mov_b32 v56, 0
  v_mov_b32 v57, 0
  v_mov_b32 v58, 0
  v_mov_b32 v59, 0
  v_mov_b32 v60, 0
  v_mov_b32 v61, 0
  v_mov_b32 v62, 0
  v_mov_b32 v63, 0
  s_mov_b32 s82, 0
  s_mov_b32 s83, 0
  v_mov_b32 v15, 163536
  s_lshl_b32 s70, s65, 2
  s_add_u32 s70, s70, 163664
  v_mov_b32 v6, s70
  s_waitcnt lgkmcnt(0)
  s_mul_i32 s66, s66, 0x9e3779b1
  s_add_u32 s66, s66, 0x7f4a7c15
  v_mov_b32 v7, s66
  s_mov_b32 s84, 0
L_lspin_6:
  ds_read_b64 v[2:3], v15 offset:0
  s_add_u32 s84, s84, 1
  s_waitcnt lgkmcnt(0)
  v_cmp_ne_u32 vcc, s66, v2
  v_cmp_ne_u32 s[6:7], s66, v3
  s_nop 0
  s_or_b64 vcc, vcc, s[6:7]
  s_cbranch_vccz L_lspin_6_x
  s_cmp_gt_u32 s84, 400000
  s_cbranch_scc0 L_lspin_6
L_lspin_6_x:
  ds_read_b128 v[64:67], v10
  ds_read_b64_tr_b16 v[80:81], v14 offset:0
  ds_read_b64_tr_b16 v[82:83], v14 offset:256
  ds_read_b64_tr_b16 v[84:85], v14 offset:8192
  ds_read_b64_tr_b16 v[86:87], v14 offset:8448
  ds_read_b64_tr_b16 v[88:89], v14 offset:16384
  ds_read_b64_tr_b16 v[90:91], v14 offset:16640
  ds_read_b128 v[68:71], v11
  ds_read_b64_tr_b16 v[92:93], v14 offset:2048
  ds_read_b64_tr_b16 v[94:95], v14 offset:2304
  ds_read_b64_tr_b16 v[96:97], v14 offset:10240
  ds_read_b64_tr_b16 v[98:99], v14 offset:10496
  ds_read_b64_tr_b16 v[100:101], v14 offset:18432
  ds_read_b64_tr_b16 v[102:103], v14 offset:18688
  ds_read_b32 v8, v15
L_g_chunk:
  s_waitcnt lgkmcnt(8)
  ds_read_b128 v[72:75], v12
  ds_read_b64_tr_b16 v[104:105], v14 offset:4096
  ds_read_b64_tr_b16 v[106:107], v14 offset:4352
  ds_read_b64_tr_b16 v[108:109], v14 offset:12288
  ds_read_b64_tr_b16 v[110:111], v14 offset:12544
  ds_read_b64_tr_b16 v[112:113], v14 offset:20480
  ds_read_b64_tr_b16 v[114:115], v14 offset:20736
  v_mfma_f32_32x32x16_bf16 v[16:31], v[80:83], v[64:67], v[16:31]
  v_mfma_f32_32x32x16_bf16 v[32:47], v[84:87], v[64:67], v[32:47]
  v_mfma_f32_32x32x16_bf16 v[48:63], v[64:67], v[88:91], v[48:63]
  s_waitcnt lgkmcnt(7)
  ds_read_b64 v[2:3], v15 offset:8
  ds_read_b128 v[76:79], v13
  ds_read_b64_tr_b16 v[116:117], v14 offset:6144
  ds_read_b64_tr_b16 v[118:119], v14 offset:6400
  ds_read_b64_tr_b16 v[120:121], v14 offset:14336
  ds_read_b64_tr_b16 v[122:123], v14 offset:14592
  ds_read_b64_tr_b16 v[124:125], v14 offset:22528
  ds_read_b64_tr_b16 v[126:127], v14 offset:22784
  v_mfma_f32_32x32x16_bf16 v[16:31], v[92:95], v[68:71], v[16:31]
  v_mfma_f32_32x32x16_bf16 v[32:47], v[96:99], v[68:71], v[32:47]
  v_mfma_f32_32x32x16_bf16 v[48:63], v[68:71], v[100:103], v[48:63]
  s_waitcnt lgkmcnt(7)
  s_add_u32 s82, s82, 1
  s_cmp_eq_u32 s82, 8
  s_cbranch_scc1 L_g_go
  v_cmp_ne_u32 vcc, s66, v2
  v_cmp_ne_u32 s[6:7], s66, v3
  s_nop 0
  s_or_b64 vcc, vcc, s[6:7]
  s_cbranch_vccnz L_g_wait
L_g_go:
  s_add_u32 s83, s83, 1
  s_mov_b32 s70, 32768
  s_cmp_eq_u32 s83, 3
  s_cselect_b32 s70, 4294901760, s70
  s_cselect_b32 s83, 0, s83
  v_add_u32 v10, s70, v10
  v_add_u32 v11, s70, v11
  v_add_u32 v12, s70, v12
  v_add_u32 v13, s70, v13
  v_add_u32 v14, s70, v14
  v_add_u32 v15, 8, v15
  ds_read_b128 v[64:67], v10
  ds_read_b64_tr_b16 v[80:81], v14 offset:0
  ds_read_b64_tr_b16 v[82:83], v14 offset:256
  ds_read_b64_tr_b16 v[84:85], v14 offset:8192
  ds_read_b64_tr_b16 v[86:87], v14 offset:8448
  ds_read_b64_tr_b16 v[88:89], v14 offset:16384
  ds_read_b64_tr_b16 v[90:91], v14 offset:16640
  v_mfma_f32_32x32x16_bf16 v[16:31], v[104:107], v[72:75], v[16:31]
  v_mfma_f32_32x32x16_bf16 v[32:47], v[108:111], v[72:75], v[32:47]
  v_mfma_f32_32x32x16_bf16 v[48:63], v[72:75], v[112:115], v[48:63]
  s_waitcnt lgkmcnt(7)
  ds_read_b128 v[68:71], v11
  ds_read_b64_tr_b16 v[92:93], v14 offset:2048
  ds_read_b64_tr_b16 v[94:95], v14 offset:2304
  ds_read_b64_tr_b16 v[96:97], v14 offset:10240
  ds_read_b64_tr_b16 v[98:99], v14 offset:10496
  ds_read_b64_tr_b16 v[100:101], v14 offset:18432
  ds_read_b64_tr_b16 v[102:103], v14 offset:18688
  ds_write_b32 v6, v7
  v_add_u32 v6, 16, v6
  v_mfma_f32_32x32x16_bf16 v[16:31], v[116:119], v[76:79], v[16:31]
  v_mfma_f32_32x32x16_bf16 v[32:47], v[120:123], v[76:79], v[32:47]
  v_mfma_f32_32x32x16_bf16 v[48:63], v[76:79], v[124:127], v[48:63]
  s_cmp_lt_u32 s82, 8
  s_cbranch_scc1 L_g_chunk
  s_waitcnt lgkmcnt(0)
  v_mov_b32 v6, 163520
  s_mov_b32 s84, 0
L_lspin_7:
  ds_read_b32 v2, v6 offset:4
  s_add_u32 s84, s84, 1
  s_waitcnt lgkmcnt(0)
  v_cmp_ne_u32 vcc, s66, v2
  s_cbranch_vccz L_lspin_7_x
  s_cmp_gt_u32 s84, 400000
  s_cbranch_scc0 L_lspin_7
L_lspin_7_x:
  ds_read_b32 v2, v6
  v_cvt_pk_bf16_f32 v72, v32, v33
  v_cvt_pk_bf16_f32 v73, v34, v35
  v_cvt_pk_bf16_f32 v74, v36, v37
  v_cvt_pk_bf16_f32 v75, v38, v39
  v_cvt_pk_bf16_f32 v76, v40, v41
  v_cvt_pk_bf16_f32 v77, v42, v43
  v_cvt_pk_bf16_f32 v78, v44, v45
  v_cvt_pk_bf16_f32 v79, v46, v47
  v_cvt_pk_bf16_f32 v80, v48, v49
  v_cvt_pk_bf16_f32 v81, v50, v51
  v_cvt_pk_bf16_f32 v82, v52, v53
  v_cvt_pk_bf16_f32 v83, v54, v55
  v_cvt_pk_bf16_f32 v84, v56, v57
  v_cvt_pk_bf16_f32 v85, v58, v59
  v_cvt_pk_bf16_f32 v86, v60, v61
  v_cvt_pk_bf16_f32 v87, v62, v63
  s_mov_b32 s77, 0x3eb8aa3b
  s_waitcnt lgkmcnt(0)
  v_readfirstlane_b32 s67, v2
  v_lshlrev_b32 v2, 4, v1
  v_bfe_u32 v4, v1, 4, 1
  v_lshlrev_b32 v4, 16, v4
  v_lshrrev_b32 v5, 5, v1
  v_lshlrev_b32 v5, 8, v5
  v_and_b32 v6, 15, v1
  v_lshl_add_u32 v5, v6, 4, v5
  v_add_u32 v3, v4, v5
  s_and_b32 s76, s65, 2
  s_lshl_b32 s71, s62, 2
  s_add_u32 s76, s76, s71
  s_lshl_b32 s75, s60, 3
  s_lshl_b32 s71, s63, 1
  s_add_u32 s75, s75, s71
  s_and_b32 s71, s65, 1
  s_add_u32 s75, s75, s71
  s_lshl_b32 s70, s76, 6
  s_add_u32 s70, s70, s75
  s_lshl_b32 s70, s70, 10
  s_add_u32 s71, s70, 10485760
  s_add_u32 s72, s71, 65536
  s_add_u32 s73, s70, 12582912
  s_cmp_eq_u32 s67, 0
  s_cbranch_scc1 L_wt_8
  buffer_store_dwordx4 v[72:75], v2, s[44:47], s71 offen
  buffer_store_dwordx4 v[76:79], v2, s[44:47], s72 offen
  buffer_store_dwordx4 v[80:83], v3, s[44:47], s73 offen
  buffer_store_dwordx4 v[84:87], v3, s[44:47], s73 offen offset:512
  s_branch L_std_9
L_wt_8:
  buffer_store_dwordx4 v[72:75], v2, s[44:47], s71 offen sc1
  buffer_store_dwordx4 v[76:79], v2, s[44:47], s72 offen sc1
  buffer_store_dwordx4 v[80:83], v3, s[44:47], s73 offen sc1
  buffer_store_dwordx4 v[84:87], v3, s[44:47], s73 offen offset:512 sc1
L_std_9:
  v_mul_f32 v16, s77, v16
  v_mul_f32 v17, s77, v17
  v_mul_f32 v18, s77, v18
  v_mul_f32 v19, s77, v19
  v_mul_f32 v20, s77, v20
  v_mul_f32 v21, s77, v21
  v_mul_f32 v22, s77, v22
  v_mul_f32 v23, s77, v23
  v_mul_f32 v24, s77, v24
  v_mul_f32 v25, s77, v25
  v_mul_f32 v26, s77, v26
  v_mul_f32 v27, s77, v27
  v_mul_f32 v28, s77, v28
  v_mul_f32 v29, s77, v29
  v_mul_f32 v30, s77, v30
  v_mul_f32 v31, s77, v31
  v_cvt_pk_bf16_f32 v64, v16, v17
  v_cvt_pk_bf16_f32 v65, v18, v19
  v_cvt_pk_bf16_f32 v66, v20, v21
  v_cvt_pk_bf16_f32 v67, v22, v23
  v_cvt_pk_bf16_f32 v68, v24, v25
  v_cvt_pk_bf16_f32 v69, v26, v27
  v_cvt_pk_bf16_f32 v70, v28, v29
  v_cvt_pk_bf16_f32 v71, v30, v31
  s_add_u32 s74, s70, 8388608
  s_add_u32 s77, s74, 65536
  s_cmp_eq_u32 s67, 0
  s_cbranch_scc1 L_wt_10
  buffer_store_dwordx4 v[64:67], v2, s[44:47], s74 offen
  buffer_store_dwordx4 v[68:71], v2, s[44:47], s77 offen
  s_branch L_std_11
L_wt_10:
  buffer_store_dwordx4 v[64:67], v2, s[44:47], s74 offen sc1
  buffer_store_dwordx4 v[68:71], v2, s[44:47], s77 offen sc1
L_std_11:
  s_lshl_b32 s71, s76, 14
  s_lshl_b32 s72, s60, 11
  s_add_u32 s71, s71, s72
  s_and_b32 s72, s75, 7
  s_lshl_b32 s72, s72, 2
  s_add_u32 s71, s71, s72
  s_add_u32 s71, s71, 1049344
  v_lshlrev_b32 v4, 14, v1
  v_mov_b32 v5, s66
  s_waitcnt vmcnt(0)
  s_mov_b64 exec, 3
  s_cmp_eq_u32 s67, 0
  s_cbranch_scc1 L_wt_12
  buffer_store_dword v5, v4, s[44:47], s71 offen
  s_branch L_std_13
L_wt_12:
  buffer_store_dword v5, v4, s[44:47], s71 offen sc1
L_std_13:
  s_mov_b64 exec, -1
  v_mov_b32 v6, 163472
  s_mov_b32 s84, 0
L_lspin_14:
  ds_read_b128 v[8:11], v6 offset:0
  s_add_u32 s84, s84, 1
  s_waitcnt lgkmcnt(0)
  v_cmp_ne_u32 vcc, s66, v8
  v_cmp_ne_u32 s[6:7], s66, v9
  s_nop 0
  s_or_b64 vcc, vcc, s[6:7]
  v_cmp_ne_u32 s[6:7], s66, v10
  s_nop 0
  s_or_b64 vcc, vcc, s[6:7]
  v_cmp_ne_u32 s[6:7], s66, v11
  s_nop 0
  s_or_b64 vcc, vcc, s[6:7]
  s_cbranch_vccz L_lspin_14_x
  s_sleep 1
  s_cmp_gt_u32 s84, 400000
  s_cbranch_scc0 L_lspin_14
L_lspin_14_x:
  s_add_u32 s71, s70, 4194304
  s_add_u32 s72, s71, 65536
  s_add_u32 s73, s70, 6291456
  buffer_store_dwordx4 v[72:75], v2, s[44:47], s71 offen sc1
  buffer_store_dwordx4 v[76:79], v2, s[44:47], s72 offen sc1
  buffer_store_dwordx4 v[80:83], v3, s[44:47], s73 offen sc1
  buffer_store_dwordx4 v[84:87], v3, s[44:47], s73 offen offset:512 sc1
  s_lshl_b32 s3, s76, 14
  s_lshl_b32 s72, s75, 2
  s_add_u32 s3, s3, s72
  s_add_u32 s3, s3, 1048576
  s_branch L_gap1_join
L_g_wait:
  s_mov_b32 s84, 0
L_lspin_15:
  ds_read_b64 v[2:3], v15 offset:8
  s_add_u32 s84, s84, 1
  s_waitcnt lgkmcnt(0)
  v_cmp_ne_u32 vcc, s66, v2
  v_cmp_ne_u32 s[6:7], s66, v3
  s_nop 0
  s_or_b64 vcc, vcc, s[6:7]
  s_cbranch_vccz L_lspin_15_x
  s_cmp_gt_u32 s84, 400000
  s_cbranch_scc0 L_lspin_15
L_lspin_15_x:
  s_branch L_g_go
L_kgen:
  s_sub_u32 s34, s65, 10
  s_lshr_b32 s3, s34, 1
  s_and_b32 s5, s34, 1
  s_lshl_b32 s70, s60, 6
  s_lshl_b32 s71, s61, 1
  s_add_u32 s70, s70, s71
  s_lshl_b32 s73, s70, 1
  s_load_dword s85, s[24:25], s73
  s_add_u32 s70, s70, s3
  s_lshl_b32 s70, s70, 8
  s_lshl_b32 s71, s5, 7
  s_add_u32 s70, s70, s71
  v_lshlrev_b32 v2, 1, v1
  v_add_u32 v2, s70, v2
  global_load_ushort v20, v2, s[16:17]
  global_load_ushort v21, v2, s[18:19]
  global_load_ushort v22, v2, s[20:21]
  global_load_ushort v23, v2, s[22:23]
  s_waitcnt lgkmcnt(0)
  s_mul_i32 s66, s66, 0x9e3779b1
  s_add_u32 s66, s66, 0x7f4a7c15
  s_lshl_b32 s72, s3, 4
  s_lshr_b32 s71, s85, s72
  s_lshl_b32 s71, s71, 16
  v_mov_b32 v4, s71
  v_mul_f32 v4, 0x3fb8aa3b, v4
  v_exp_f32 v4, v4
  s_mul_i32 s4, s34, 15504
  s_add_u32 s4, s4, 98304
  v_lshlrev_b32 v8, 2, v1
  v_add_u32 v8, s4, v8
  s_waitcnt vmcnt(0)
  v_lshlrev_b32 v20, 16, v20
  v_lshlrev_b32 v21, 16, v21
  v_lshlrev_b32 v22, 16, v22
  v_lshlrev_b32 v23, 16, v23
  v_mul_f32 v20, 0x3fb8aa3b, v20
  v_exp_f32 v20, v20
  s_nop 0
  v_cvt_pk_bf16_f32 v5, v4, v20
  v_and_b32 v20, 0xffff0000, v5
  v_lshlrev_b32 v5, 16, v5
  v_mul_f32 v20, v20, v5
  v_mul_f32 v21, v21, v5
  v_mul_f32 v22, v22, v5
  v_mul_f32 v23, v23, v5
  v_mul_f32 v20, 0xbfb8aa3b, v20
  v_mul_f32 v21, 0x3e22f983, v21
  v_add_f32 v34, v22, v22
  v_add_f32 v35, v23, v23
  v_mul_f32 v6, 0x3f800000, v20
  v_mul_f32 v7, 0x3f800000, v21
  v_exp_f32 v6, v6
  v_fract_f32 v7, v7
  v_cos_f32 v24, v7
  v_sin_f32 v25, v7
  s_nop 0
  v_mul_f32 v24, v6, v24
  v_mul_f32 v25, v6, v25
  v_mul_f32 v6, 0x40800000, v20
  v_mul_f32 v7, 0x40800000, v21
  v_exp_f32 v6, v6
  v_fract_f32 v7, v7
  v_cos_f32 v30, v7
  v_sin_f32 v31, v7
  s_nop 0
  v_mul_f32 v30, v6, v30
  v_mul_f32 v31, v6, v31
  v_mul_f32 v6, 0x43000000, v20
  v_mul_f32 v7, 0x43000000, v21
  v_exp_f32 v6, v6
  v_fract_f32 v7, v7
  v_cos_f32 v32, v7
  v_sin_f32 v33, v7
  s_nop 0
  v_mul_f32 v32, v6, v32
  v_mul_f32 v33, v6, v33
  v_mul_f32 v26, v24, v24
  v_mul_f32 v27, v24, v25
  v_fma_f32 v26, -v25, v25, v26
  v_fma_f32 v27, v25, v24, v27
  v_mul_f32 v28, v26, v24
  v_mul_f32 v29, v26, v25
  v_fma_f32 v28, -v27, v25, v28
  v_fma_f32 v29, v27, v24, v29
  v_mov_b32 v36, v34
  v_mov_b32 v37, v35
  v_mov_b32 v42, 1.0
  v_mov_b32 v43, 0
  v_add_u32 v9, 6800, v8
  v_mov_b32 v10, v8
  s_mov_b32 s82, 0
L_kg_chain:
  v_cvt_pk_bf16_f32 v46, v36, v37
  v_mul_f32 v38, v36, v32
  v_mul_f32 v39, v36, v33
  v_fma_f32 v38, -v37, v33, v38
  v_fma_f32 v39, v37, v32, v39
  v_cvt_pk_bf16_f32 v47, v42, -v43
  v_mul_f32 v44, v42, v30
  v_mul_f32 v45, v42, v31
  v_fma_f32 v44, -v43, v31, v44
  v_fma_f32 v45, v43, v30, v45
  v_cvt_pk_bf16_f32 v48, v44, -v45
  v_mul_f32 v42, v44, v30
  v_mul_f32 v43, v44, v31
  v_fma_f32 v42, -v45, v31, v42
  v_fma_f32 v43, v45, v30, v43
  ds_write_b32 v10, v46 offset:0
  ds_write_b32 v9, v47 offset:0
  ds_write_b32 v9, v48 offset:272
  v_cvt_pk_bf16_f32 v46, v38, v39
  v_mul_f32 v36, v38, v32
  v_mul_f32 v37, v38, v33
  v_fma_f32 v36, -v39, v33, v36
  v_fma_f32 v37, v39, v32, v37
  v_cvt_pk_bf16_f32 v47, v42, -v43
  v_mul_f32 v44, v42, v30
  v_mul_f32 v45, v42, v31
  v_fma_f32 v44, -v43, v31, v44
  v_fma_f32 v45, v43, v30, v45
  v_cvt_pk_bf16_f32 v48, v44, -v45
  v_mul_f32 v42, v44, v30
  v_mul_f32 v43, v44, v31
  v_fma_f32 v42, -v45, v31, v42
  v_fma_f32 v43, v45, v30, v43
  ds_write_b32 v10, v46 offset:1088
  ds_write_b32 v9, v47 offset:544
  ds_write_b32 v9, v48 offset:816
  v_cvt_pk_bf16_f32 v46, v36, v37
  v_mul_f32 v38, v36, v32
  v_mul_f32 v39, v36, v33
  v_fma_f32 v38, -v37, v33, v38
  v_fma_f32 v39, v37, v32, v39
  v_cvt_pk_bf16_f32 v47, v42, -v43
  v_mul_f32 v44, v42, v30
  v_mul_f32 v45, v42, v31
  v_fma_f32 v44, -v43, v31, v44
  v_fma_f32 v45, v43, v30, v45
  v_cvt_pk_bf16_f32 v48, v44, -v45
  v_mul_f32 v42, v44, v30
  v_mul_f32 v43, v44, v31
  v_fma_f32 v42, -v45, v31, v42
  v_fma_f32 v43, v45, v30, v43
  ds_write_b32 v10, v46 offset:272
  ds_write_b32 v9, v47 offset:1088
  ds_write_b32 v9, v48 offset:1360
  v_cvt_pk_bf16_f32 v46, v38, v39
  v_mul_f32 v36, v38, v32
  v_mul_f32 v37, v38, v33
  v_fma_f32 v36, -v39, v33, v36
  v_fma_f32 v37, v39, v32, v37
  v_cvt_pk_bf16_f32 v47, v42, -v43
  v_mul_f32 v44, v42, v30
  v_mul_f32 v45, v42, v31
  v_fma_f32 v44, -v43, v31, v44
  v_fma_f32 v45, v43, v30, v45
  v_cvt_pk_bf16_f32 v48, v44, -v45
  v_mul_f32 v42, v44, v30
  v_mul_f32 v43, v44, v31
  v_fma_f32 v42, -v45, v31, v42
  v_fma_f32 v43, v45, v30, v43
  ds_write_b32 v10, v46 offset:1360
  ds_write_b32 v9, v47 offset:1632
  ds_write_b32 v9, v48 offset:1904
  v_cvt_pk_bf16_f32 v46, v36, v37
  v_mul_f32 v38, v36, v32
  v_mul_f32 v39, v36, v33
  v_fma_f32 v38, -v37, v33, v38
  v_fma_f32 v39, v37, v32, v39
  v_cvt_pk_bf16_f32 v47, v42, -v43
  v_mul_f32 v44, v42, v30
  v_mul_f32 v45, v42, v31
  v_fma_f32 v44, -v43, v31, v44
  v_fma_f32 v45, v43, v30, v45
  v_cvt_pk_bf16_f32 v48, v44, -v45
  v_mul_f32 v42, v44, v30
  v_mul_f32 v43, v44, v31
  v_fma_f32 v42, -v45, v31, v42
  v_fma_f32 v43, v45, v30, v43
  ds_write_b32 v10, v46 offset:544
  ds_write_b32 v9, v47 offset:2176
  ds_write_b32 v9, v48 offset:2448
  v_cvt_pk_bf16_f32 v46, v38, v39
  v_mul_f32 v36, v38, v32
  v_mul_f32 v37, v38, v33
  v_fma_f32 v36, -v39, v33, v36
  v_fma_f32 v37, v39, v32, v37
  v_cvt_pk_bf16_f32 v47, v42, -v43
  v_mul_f32 v44, v42, v30
  v_mul_f32 v45, v42, v31
  v_fma_f32 v44, -v43, v31, v44
  v_fma_f32 v45, v43, v30, v45
  v_cvt_pk_bf16_f32 v48, v44, -v45
  v_mul_f32 v42, v44, v30
  v_mul_f32 v43, v44, v31
  v_fma_f32 v42, -v45, v31, v42
  v_fma_f32 v43, v45, v30, v43
  ds_write_b32 v10, v46 offset:1632
  ds_write_b32 v9, v47 offset:2720
  ds_write_b32 v9, v48 offset:2992
  v_cvt_pk_bf16_f32 v46, v36, v37
  v_mul_f32 v38, v36, v32
  v_mul_f32 v39, v36, v33
  v_fma_f32 v38, -v37, v33, v38
  v_fma_f32 v39, v37, v32, v39
  v_cvt_pk_bf16_f32 v47, v42, -v43
  v_mul_f32 v44, v42, v30
  v_mul_f32 v45, v42, v31
  v_fma_f32 v44, -v43, v31, v44
  v_fma_f32 v45, v43, v30, v45
  v_cvt_pk_bf16_f32 v48, v44, -v45
  v_mul_f32 v42, v44, v30
  v_mul_f32 v43, v44, v31
  v_fma_f32 v42, -v45, v31, v42
  v_fma_f32 v43, v45, v30, v43
  ds_write_b32 v10, v46 offset:816
  ds_write_b32 v9, v47 offset:3264
  ds_write_b32 v9, v48 offset:3536
  v_cvt_pk_bf16_f32 v46, v38, v39
  v_mul_f32 v36, v38, v32
  v_mul_f32 v37, v38, v33
  v_fma_f32 v36, -v39, v33, v36
  v_fma_f32 v37, v39, v32, v37
  v_cvt_pk_bf16_f32 v47, v42, -v43
  v_mul_f32 v44, v42, v30
  v_mul_f32 v45, v42, v31
  v_fma_f32 v44, -v43, v31, v44
  v_fma_f32 v45, v43, v30, v45
  v_cvt_pk_bf16_f32 v48, v44, -v45
  v_mul_f32 v42, v44, v30
  v_mul_f32 v43, v44, v31
  v_fma_f32 v42, -v45, v31, v42
  v_fma_f32 v43, v45, v30, v43
  ds_write_b32 v10, v46 offset:1904
  ds_write_b32 v9, v47 offset:3808
  ds_write_b32 v9, v48 offset:4080
  v_add_u32 v10, 2176, v10
  v_add_u32 v9, 4352, v9
  s_add_u32 s82, s82, 1
  s_cmp_lt_u32 s82, 2
  s_cbranch_scc1 L_kg_chain
  v_cvt_pk_bf16_f32 v46, v36, v37
  ds_write_b32 v8, v46 offset:6528
  v_mul_f32 v36, v34, v24
  v_mul_f32 v37, v34, v25
  v_fma_f32 v36, -v35, v25, v36
  v_fma_f32 v37, v35, v24, v37
  v_mul_f32 v38, v36, v32
  v_mul_f32 v39, v36, v33
  v_fma_f32 v38, -v37, v33, v38
  v_fma_f32 v39, v37, v32, v39
  v_cvt_pk_bf16_f32 v46, v36, v37
  v_cvt_pk_bf16_f32 v47, v38, v39
  ds_write_b32 v8, v46 offset:4352
  ds_write_b32 v8, v47 offset:5440
  v_mul_f32 v36, v34, v26
  v_mul_f32 v37, v34, v27
  v_fma_f32 v36, -v35, v27, v36
  v_fma_f32 v37, v35, v26, v37
  v_mul_f32 v38, v36, v32
  v_mul_f32 v39, v36, v33
  v_fma_f32 v38, -v37, v33, v38
  v_fma_f32 v39, v37, v32, v39
  v_cvt_pk_bf16_f32 v46, v36, v37
  v_cvt_pk_bf16_f32 v47, v38, v39
  v_mul_f32 v40, v38, v32
  v_mul_f32 v41, v38, v33
  v_fma_f32 v40, -v39, v33, v40
  v_fma_f32 v41, v39, v32, v41
  ds_write_b32 v8, v46 offset:4624
  ds_write_b32 v8, v47 offset:5712
  v_mul_f32 v36, v34, v28
  v_mul_f32 v37, v34, v29
  v_fma_f32 v36, -v35, v29, v36
  v_fma_f32 v37, v35, v28, v37
  v_mul_f32 v38, v36, v32
  v_mul_f32 v39, v36, v33
  v_fma_f32 v38, -v37, v33, v38
  v_fma_f32 v39, v37, v32, v39
  v_cvt_pk_bf16_f32 v46, v36, v37
  v_cvt_pk_bf16_f32 v47, v38, v39
  ds_write_b32 v8, v46 offset:4896
  ds_write_b32 v8, v47 offset:5984
  v_mul_f32 v38, v40, v32
  v_mul_f32 v39, v40, v33
  v_fma_f32 v38, -v41, v33, v38
  v_fma_f32 v39, v41, v32, v39
  v_cvt_pk_bf16_f32 v46, v40, v41
  v_cvt_pk_bf16_f32 v47, v38, v39
  ds_write_b32 v8, v46 offset:5168
  ds_write_b32 v8, v47 offset:6256
  v_mov_b32 v10, 163664
  s_mov_b32 s84, 0
L_lspin_16:
  ds_read_b128 v[12:15], v10 offset:80
  s_add_u32 s84, s84, 1
  s_waitcnt lgkmcnt(0)
  v_cmp_ne_u32 vcc, s66, v12
  v_cmp_ne_u32 s[6:7], s66, v13
  s_nop 0
  s_or_b64 vcc, vcc, s[6:7]
  v_cmp_ne_u32 s[6:7], s66, v14
  s_nop 0
  s_or_b64 vcc, vcc, s[6:7]
  v_cmp_ne_u32 s[6:7], s66, v15
  s_nop 0
  s_or_b64 vcc, vcc, s[6:7]
  s_cbranch_vccz L_lspin_16_x
  s_sleep 8
  s_cmp_gt_u32 s84, 400000
  s_cbranch_scc0 L_lspin_16
L_lspin_16_x:
  v_and_b32 v4, 31, v1
  v_mul_u32_u24 v4, 272, v4
  v_lshrrev_b32 v5, 5, v1
  v_lshl_add_u32 v4, v5, 4, v4
  v_add_u32 v2, s4, v4
  v_add_u32 v3, 6800, v2
  s_waitcnt lgkmcnt(0)
  ds_read_b128 v[64:67], v2 offset:0
  ds_read_b128 v[68:71], v3 offset:0
  ds_read_b128 v[72:75], v2 offset:32
  ds_read_b128 v[76:79], v3 offset:32
  ds_read_b128 v[80:83], v2 offset:64
  ds_read_b128 v[84:87], v3 offset:64
  ds_read_b128 v[88:91], v2 offset:96
  ds_read_b128 v[92:95], v3 offset:96
  ds_read_b128 v[96:99], v2 offset:128
  ds_read_b128 v[100:103], v3 offset:128
  ds_read_b128 v[104:107], v2 offset:160
  ds_read_b128 v[108:111], v3 offset:160
  s_waitcnt lgkmcnt(10)
  v_mfma_f32_32x32x16_bf16 v[48:63], v[64:67], v[68:71], 0
  ds_read_b128 v[112:115], v2 offset:192
  ds_read_b128 v[116:119], v3 offset:192
  s_waitcnt lgkmcnt(10)
  v_mfma_f32_32x32x16_bf16 v[48:63], v[72:75], v[76:79], v[48:63]
  ds_read_b128 v[120:123], v2 offset:224
  ds_read_b128 v[124:127], v3 offset:224
  s_waitcnt lgkmcnt(10)
  v_mfma_f32_32x32x16_bf16 v[48:63], v[80:83], v[84:87], v[48:63]
  s_waitcnt lgkmcnt(8)
  v_mfma_f32_32x32x16_bf16 v[48:63], v[88:91], v[92:95], v[48:63]
  s_waitcnt lgkmcnt(6)
  v_mfma_f32_32x32x16_bf16 v[48:63], v[96:99], v[100:103], v[48:63]
  s_waitcnt lgkmcnt(4)
  v_mfma_f32_32x32x16_bf16 v[48:63], v[104:107], v[108:111], v[48:63]
  s_waitcnt lgkmcnt(2)
  v_mfma_f32_32x32x16_bf16 v[48:63], v[112:115], v[116:119], v[48:63]
  s_waitcnt lgkmcnt(0)
  v_mfma_f32_32x32x16_bf16 v[48:63], v[120:123], v[124:127], v[48:63]
  s_mov_b32 s70, s34
  s_lshl_b32 s71, s70, 2
  s_add_u32 s71, s71, 163488
  v_mov_b32 v6, s71
  v_mov_b32 v7, s66
  ds_write_b32 v6, v7
  v_mov_b32 v10, 163488
  s_mov_b32 s84, 0
L_lspin_17:
  ds_read_b128 v[12:15], v10 offset:0
  s_add_u32 s84, s84, 1
  s_waitcnt lgkmcnt(0)
  v_cmp_ne_u32 vcc, s66, v12
  v_cmp_ne_u32 s[6:7], s66, v13
  s_nop 0
  s_or_b64 vcc, vcc, s[6:7]
  v_cmp_ne_u32 s[6:7], s66, v14
  s_nop 0
  s_or_b64 vcc, vcc, s[6:7]
  v_cmp_ne_u32 s[6:7], s66, v15
  s_nop 0
  s_or_b64 vcc, vcc, s[6:7]
  s_cbranch_vccz L_lspin_17_x
  s_sleep 2
  s_cmp_gt_u32 s84, 400000
  s_cbranch_scc0 L_lspin_17
L_lspin_17_x:
  s_lshl_b32 s71, s70, 12
  s_add_u32 s71, s71, 98304
  v_lshlrev_b32 v11, 4, v1
  v_add_u32 v12, s71, v11
  ds_write_b128 v12, v[48:51] offset:0
  ds_write_b128 v12, v[52:55] offset:1024
  ds_write_b128 v12, v[56:59] offset:2048
  ds_write_b128 v12, v[60:63] offset:3072
  s_waitcnt lgkmcnt(0)
  ds_write_b32 v6, v7 offset:16
  v_xor_b32 v6, 4, v6
  v_xor_b32 v12, 4096, v12
  s_mov_b32 s84, 0
L_lspin_18:
  ds_read_b32 v14, v6 offset:16
  s_add_u32 s84, s84, 1
  s_waitcnt lgkmcnt(0)
  v_cmp_ne_u32 vcc, s66, v14
  s_cbranch_vccz L_lspin_18_x
  s_sleep 1
  s_cmp_gt_u32 s84, 400000
  s_cbranch_scc0 L_lspin_18
L_lspin_18_x:
  ds_read_b128 v[64:67], v12 offset:0
  ds_read_b128 v[68:71], v12 offset:1024
  ds_read_b128 v[72:75], v12 offset:2048
  ds_read_b128 v[76:79], v12 offset:3072
  s_mul_i32 s4, s3, 4608
  s_add_u32 s4, s4, 114688
  v_and_b32 v4, 31, v1
  v_lshlrev_b32 v4, 3, v4
  v_lshl_add_u32 v4, v5, 8, v4
  v_add_u32 v4, s4, v4
  s_waitcnt lgkmcnt(0)
  v_add_f32 v48, v48, v64
  v_add_f32 v49, v49, v65
  v_add_f32 v50, v50, v66
  v_add_f32 v51, v51, v67
  v_add_f32 v52, v52, v68
  v_add_f32 v53, v53, v69
  v_add_f32 v54, v54, v70
  v_add_f32 v55, v55, v71
  v_add_f32 v56, v56, v72
  v_add_f32 v57, v57, v73
  v_add_f32 v58, v58, v74
  v_add_f32 v59, v59, v75
  v_add_f32 v60, v60, v76
  v_add_f32 v61, v61, v77
  v_cvt_pk_bf16_f32 v80, v48, v49
  v_cvt_pk_bf16_f32 v81, v50, v51
  v_cvt_pk_bf16_f32 v82, v52, v53
  v_cvt_pk_bf16_f32 v83, v54, v55
  v_cvt_pk_bf16_f32 v84, v56, v57
  v_cvt_pk_bf16_f32 v85, v58, v59
  v_cvt_pk_bf16_f32 v86, v60, v61
  ds_write_b16 v4, v80 offset:0
  ds_write_b16_d16_hi v4, v80 offset:512
  ds_write_b16 v4, v81 offset:1024
  ds_write_b16_d16_hi v4, v81 offset:1536
  ds_write_b16 v4, v82 offset:2048
  ds_write_b16_d16_hi v4, v82 offset:2560
  ds_write_b16 v4, v83 offset:3072
  ds_write_b16_d16_hi v4, v83 offset:3584
  ds_write_b16 v4, v84 offset:2
  ds_write_b16_d16_hi v4, v84 offset:4
  ds_write_b16 v4, v85 offset:6
  ds_write_b16_d16_hi v4, v85 offset:516
  ds_write_b16 v4, v86 offset:4096
  s_mul_i32 s73, s3, 8320
  s_lshl_b32 s71, s5, 11
  s_add_u32 s73, s73, s71
  s_add_u32 s73, s73, 131072
  v_lshlrev_b32 v8, 2, v1
  v_add_u32 v8, s73, v8
  s_lshl_b32 s71, s5, 10
  s_sub_u32 s71, 2047, s71
  v_lshlrev_b32 v9, 1, v1
  v_sub_u32 v9, s71, v9
  v_cvt_f32_i32 v9, v9
  s_waitcnt lgkmcnt(0)
  v_add_f32 v20, 0x80000000, v9
  v_add_f32 v21, -1.0, v20
  v_cvt_pk_bf16_f32 v20, v20, v21
  v_and_b32 v21, 0xffff0000, v20
  v_lshlrev_b32 v20, 16, v20
  v_cvt_u32_f32 v20, v20
  v_cvt_u32_f32 v21, v21
  v_lshl_add_u32 v20, v20, 1, s4
  v_lshl_add_u32 v21, v21, 1, s4
  ds_read_u16 v22, v20
  ds_read_u16_d16_hi v23, v21
  v_add_f32 v24, 0xc3000000, v9
  v_add_f32 v25, -1.0, v24
  v_cvt_pk_bf16_f32 v24, v24, v25
  v_and_b32 v25, 0xffff0000, v24
  v_lshlrev_b32 v24, 16, v24
  v_cvt_u32_f32 v24, v24
  v_cvt_u32_f32 v25, v25
  v_lshl_add_u32 v24, v24, 1, s4
  v_lshl_add_u32 v25, v25, 1, s4
  ds_read_u16 v26, v24
  ds_read_u16_d16_hi v27, v25
  v_add_f32 v28, 0xc3800000, v9
  v_add_f32 v29, -1.0, v28
  v_cvt_pk_bf16_f32 v28, v28, v29
  v_and_b32 v29, 0xffff0000, v28
  v_lshlrev_b32 v28, 16, v28
  v_cvt_u32_f32 v28, v28
  v_cvt_u32_f32 v29, v29
  v_lshl_add_u32 v28, v28, 1, s4
  v_lshl_add_u32 v29, v29, 1, s4
  ds_read_u16 v30, v28
  ds_read_u16_d16_hi v31, v29
  v_add_f32 v32, 0xc3c00000, v9
  v_add_f32 v33, -1.0, v32
  v_cvt_pk_bf16_f32 v32, v32, v33
  v_and_b32 v33, 0xffff0000, v32
  v_lshlrev_b32 v32, 16, v32
  v_cvt_u32_f32 v32, v32
  v_cvt_u32_f32 v33, v33
  v_lshl_add_u32 v32, v32, 1, s4
  v_lshl_add_u32 v33, v33, 1, s4
  ds_read_u16 v34, v32
  ds_read_u16_d16_hi v35, v33
  v_add_f32 v36, 0xc4000000, v9
  v_add_f32 v37, -1.0, v36
  v_cvt_pk_bf16_f32 v36, v36, v37
  v_and_b32 v37, 0xffff0000, v36
  v_lshlrev_b32 v36, 16, v36
  v_cvt_u32_f32 v36, v36
  v_cvt_u32_f32 v37, v37
  v_lshl_add_u32 v36, v36, 1, s4
  v_lshl_add_u32 v37, v37, 1, s4
  ds_read_u16 v38, v36
  ds_read_u16_d16_hi v39, v37
  s_waitcnt lgkmcnt(0)
  v_or_b32 v22, v22, v23
  ds_write_b32 v8, v22 offset:0
  v_or_b32 v26, v26, v27
  ds_write_b32 v8, v26 offset:256
  v_or_b32 v30, v30, v31
  ds_write_b32 v8, v30 offset:512
  v_or_b32 v34, v34, v35
  ds_write_b32 v8, v34 offset:768
  v_or_b32 v38, v38, v39
  ds_write_b32 v8, v38 offset:1024
  v_add_f32 v20, 0xc4200000, v9
  v_add_f32 v21, -1.0, v20
  v_cvt_pk_bf16_f32 v20, v20, v21
  v_and_b32 v21, 0xffff0000, v20
  v_lshlrev_b32 v20, 16, v20
  v_cvt_u32_f32 v20, v20
  v_cvt_u32_f32 v21, v21
  v_lshl_add_u32 v20, v20, 1, s4
  v_lshl_add_u32 v21, v21, 1, s4
  ds_read_u16 v22, v20
  ds_read_u16_d16_hi v23, v21
  v_add_f32 v24, 0xc4400000, v9
  v_add_f32 v25, -1.0, v24
  v_cvt_pk_bf16_f32 v24, v24, v25
  v_and_b32 v25, 0xffff0000, v24
  v_lshlrev_b32 v24, 16, v24
  v_cvt_u32_f32 v24, v24
  v_cvt_u32_f32 v25, v25
  v_lshl_add_u32 v24, v24, 1, s4
  v_lshl_add_u32 v25, v25, 1, s4
  ds_read_u16 v26, v24
  ds_read_u16_d16_hi v27, v25
  v_add_f32 v28, 0xc4600000, v9
  v_add_f32 v29, -1.0, v28
  v_cvt_pk_bf16_f32 v28, v28, v29
  v_and_b32 v29, 0xffff0000, v28
  v_lshlrev_b32 v28, 16, v28
  v_cvt_u32_f32 v28, v28
  v_cvt_u32_f32 v29, v29
  v_lshl_add_u32 v28, v28, 1, s4
  v_lshl_add_u32 v29, v29, 1, s4
  ds_read_u16 v30, v28
  ds_read_u16_d16_hi v31, v29
  v_add_f32 v32, 0xc4800000, v9
  v_add_f32 v33, -1.0, v32
  v_cvt_pk_bf16_f32 v32, v32, v33
  v_and_b32 v33, 0xffff0000, v32
  v_lshlrev_b32 v32, 16, v32
  v_cvt_u32_f32 v32, v32
  v_cvt_u32_f32 v33, v33
  v_lshl_add_u32 v32, v32, 1, s4
  v_lshl_add_u32 v33, v33, 1, s4
  ds_read_u16 v34, v32
  ds_read_u16_d16_hi v35, v33
  s_waitcnt lgkmcnt(0)
  v_or_b32 v22, v22, v23
  ds_write_b32 v8, v22 offset:1280
  v_or_b32 v26, v26, v27
  ds_write_b32 v8, v26 offset:1536
  v_or_b32 v30, v30, v31
  ds_write_b32 v8, v30 offset:1792
  v_or_b32 v34, v34, v35
  s_cmp_eq_u32 s5, 0
  s_cselect_b32 s71, -1, 0
  v_and_b32 v34, s71, v34
  s_cselect_b32 s74, 1, 0xff
  s_mov_b32 s75, 0
  s_mov_b64 exec, s[74:75]
  ds_write_b32 v8, v34 offset:2048
  s_mov_b64 exec, -1
  s_waitcnt lgkmcnt(0)
  v_add_u32 v10, 0, v8
  ds_read2_b32 v[20:21], v10 offset0:0 offset1:1
  ds_read2_b32 v[22:23], v10 offset0:64 offset1:65
  ds_read2_b32 v[24:25], v10 offset0:128 offset1:129
  ds_read2_b32 v[26:27], v10 offset0:192 offset1:193
  v_add_u32 v10, 1024, v8
  ds_read2_b32 v[28:29], v10 offset0:0 offset1:1
  ds_read2_b32 v[30:31], v10 offset0:64 offset1:65
  ds_read2_b32 v[32:33], v10 offset0:128 offset1:129
  ds_read2_b32 v[34:35], v10 offset0:192 offset1:193
  s_waitcnt lgkmcnt(0)
  v_alignbit_b32 v20, v21, v20, 16
  ds_write_b32 v8, v20 offset:4160
  v_alignbit_b32 v22, v23, v22, 16
  ds_write_b32 v8, v22 offset:4416
  v_alignbit_b32 v24, v25, v24, 16
  ds_write_b32 v8, v24 offset:4672
  v_alignbit_b32 v26, v27, v26, 16
  ds_write_b32 v8, v26 offset:4928
  v_alignbit_b32 v28, v29, v28, 16
  ds_write_b32 v8, v28 offset:5184
  v_alignbit_b32 v30, v31, v30, 16
  ds_write_b32 v8, v30 offset:5440
  v_alignbit_b32 v32, v33, v32, 16
  ds_write_b32 v8, v32 offset:5696
  v_alignbit_b32 v34, v35, v34, 16
  ds_write_b32 v8, v34 offset:5952
  s_cmp_eq_u32 s5, 0
  s_cbranch_scc1 L_gap1_join
  v_mov_b32 v4, 0
  s_mov_b64 exec, 0x7f
  ds_write_b32 v8, v4 offset:6208
  s_mov_b64 exec, -1
  s_branch L_gap1_join
L_side:
  s_cmp_eq_u32 s65, 14
  s_cbranch_scc1 L_ustage
  s_waitcnt lgkmcnt(0)
  s_mul_i32 s66, s66, 0x9e3779b1
  s_add_u32 s66, s66, 0x7f4a7c15
  s_add_u32 s70, s86, 768
  v_lshlrev_b32 v2, 4, v1
  s_mov_b32 exec_hi, 0xffff
  buffer_load_dwordx4 v[12:15], v2, s[44:47], s70 offen sc1
  s_mov_b64 exec, -1
  v_lshlrev_b32 v2, 14, v1
  s_lshl_b32 s70, s60, 11
  s_lshl_b32 s71, s61, 2
  s_add_u32 s70, s70, s71
  s_add_u32 s70, s70, 1049088
  s_xor_b32 s71, s66, s69
  s_xor_b32 s71, s71, 0x80
  v_mov_b32 v3, s71
  v_lshlrev_b32 v9, 2, v1
  s_add_u32 s72, s86, 512
  v_add_u32 v9, s72, v9
  s_mov_b32 exec_hi, 0x0
  buffer_store_dword v3, v2, s[44:47], s70 offen sc1
  s_mov_b64 exec, -1
  v_mov_b32 v17, 163536
  s_mov_b32 s84, 0
L_lspin_19:
  ds_read_b64 v[12:13], v17 offset:0
  s_add_u32 s84, s84, 1
  s_waitcnt lgkmcnt(0)
  v_cmp_ne_u32 vcc, s66, v12
  v_cmp_ne_u32 s[6:7], s66, v13
  s_nop 0
  s_or_b64 vcc, vcc, s[6:7]
  s_cbranch_vccz L_lspin_19_x
  s_sleep 4
  s_cmp_gt_u32 s84, 400000
  s_cbranch_scc0 L_lspin_19
L_lspin_19_x:
  s_mov_b32 exec_hi, 0x0
  s_mov_b32 s84, 0
L_x_poll:
  buffer_load_dword v8, v9, s[44:47], 0 offen sc1
  s_add_u32 s84, s84, 1
  s_waitcnt vmcnt(0)
  v_xor_b32 v7, s66, v8
  v_and_b32 v7, -16, v7
  v_cmp_ne_u32 vcc, 0x80, v7
  s_cmp_gt_u32 s84, 400000
  s_cbranch_scc1 L_x_ok
  s_cbranch_vccnz L_x_poll
L_x_ok:
  v_cmp_ne_u32 vcc, s71, v8
  s_nop 1
  s_cmp_eq_u64 vcc, 0
  s_cselect_b32 s67, 1, 0
  s_mov_b64 exec, -1
  v_mov_b32 v6, 163520
  v_mov_b32 v10, s67
  v_mov_b32 v11, s66
  ds_write_b64 v6, v[10:11]
  v_mov_b32 v17, 163488
  s_mov_b32 s84, 0
L_lspin_20:
  ds_read_b128 v[12:15], v17 offset:0
  s_add_u32 s84, s84, 1
  s_waitcnt lgkmcnt(0)
  v_cmp_ne_u32 vcc, s66, v12
  v_cmp_ne_u32 s[6:7], s66, v13
  s_nop 0
  s_or_b64 vcc, vcc, s[6:7]
  v_cmp_ne_u32 s[6:7], s66, v14
  s_nop 0
  s_or_b64 vcc, vcc, s[6:7]
  v_cmp_ne_u32 s[6:7], s66, v15
  s_nop 0
  s_or_b64 vcc, vcc, s[6:7]
  s_cbranch_vccz L_lspin_20_x
  s_sleep 8
  s_cmp_gt_u32 s84, 400000
  s_cbranch_scc0 L_lspin_20
L_lspin_20_x:
  v_lshlrev_b32 v2, 2, v1
  s_add_u32 s70, s86, 640
  v_add_u32 v2, s70, v2
  s_mov_b32 s84, 0
  s_mov_b32 exec_hi, 0x0
  buffer_load_dword v3, v2, s[44:47], 0 offen sc1
L_uf_21:
  s_waitcnt vmcnt(0)
  v_cmp_ne_u32 vcc, s66, v3
  s_add_u32 s84, s84, 1
  s_nop 0
  s_and_b64 vcc, vcc, exec
  s_cbranch_scc0 L_uf_ok_22
  s_cmp_gt_u32 s84, 400000
  s_cbranch_scc1 L_uf_ok_22
  buffer_load_dword v3, v2, s[44:47], 0 offen sc1
  s_branch L_uf_21
L_uf_ok_22:
  s_mov_b64 exec, -1
  v_lshlrev_b32 v4, 4, v1
  s_lshl_b32 s70, s60, 18
  s_lshl_b32 s71, s61, 13
  s_add_u32 s70, s70, s71
  s_add_u32 s70, s70, 2097152
  s_mov_b32 m0, 148224
  s_add_u32 s71, s70, 0
  buffer_load_dwordx4 v4, s[44:47], s71 offen sc1 lds
  s_mov_b32 m0, 149248
  s_add_u32 s71, s70, 1024
  buffer_load_dwordx4 v4, s[44:47], s71 offen sc1 lds
  s_mov_b32 m0, 150272
  s_add_u32 s71, s70, 2048
  buffer_load_dwordx4 v4, s[44:47], s71 offen sc1 lds
  s_mov_b32 m0, 151296
  s_add_u32 s71, s70, 3072
  buffer_load_dwordx4 v4, s[44:47], s71 offen sc1 lds
  s_mov_b32 m0, 152832
  s_add_u32 s71, s70, 4096
  buffer_load_dwordx4 v4, s[44:47], s71 offen sc1 lds
  s_mov_b32 m0, 153856
  s_add_u32 s71, s70, 5120
  buffer_load_dwordx4 v4, s[44:47], s71 offen sc1 lds
  s_mov_b32 m0, 154880
  s_add_u32 s71, s70, 6144
  buffer_load_dwordx4 v4, s[44:47], s71 offen sc1 lds
  s_mov_b32 m0, 155904
  s_add_u32 s71, s70, 7168
  buffer_load_dwordx4 v4, s[44:47], s71 offen sc1 lds
  v_lshlrev_b32 v2, 3, v1
  v_add_u32 v2, 147712, v2
  v_mov_b32 v10, 0
  v_mov_b32 v11, 0
  ds_write_b64 v2, v[10:11]
  ds_write_b64 v2, v[10:11] offset:4608
  s_waitcnt vmcnt(0)
  s_branch L_gap1_join
L_ustage:
  v_lshrrev_b32 v3, 3, v1
  v_lshlrev_b32 v3, 10, v3
  v_and_b32 v2, 7, v1
  v_lshl_add_u32 v3, v2, 4, v3
  s_lshl_b32 s70, s61, 16
  s_lshl_b32 s71, s60, 7
  s_add_u32 s72, s70, s71
  s_mov_b32 m0, 65536
  s_add_u32 s71, s72, 0
  buffer_load_dwordx4 v3, s[48:51], s71 offen lds
  s_mov_b32 m0, 66560
  s_add_u32 s71, s72, 8192
  buffer_load_dwordx4 v3, s[48:51], s71 offen lds
  s_mov_b32 m0, 67584
  s_add_u32 s71, s72, 16384
  buffer_load_dwordx4 v3, s[48:51], s71 offen lds
  s_mov_b32 m0, 68608
  s_add_u32 s71, s72, 24576
  buffer_load_dwordx4 v3, s[48:51], s71 offen lds
  s_mov_b32 m0, 69632
  s_add_u32 s71, s72, 32768
  buffer_load_dwordx4 v3, s[48:51], s71 offen lds
  s_mov_b32 m0, 70656
  s_add_u32 s71, s72, 40960
  buffer_load_dwordx4 v3, s[48:51], s71 offen lds
  s_mov_b32 m0, 71680
  s_add_u32 s71, s72, 49152
  buffer_load_dwordx4 v3, s[48:51], s71 offen lds
  s_mov_b32 m0, 72704
  s_add_u32 s71, s72, 57344
  buffer_load_dwordx4 v3, s[48:51], s71 offen lds
  s_waitcnt lgkmcnt(0)
  s_mul_i32 s66, s66, 0x9e3779b1
  s_add_u32 s66, s66, 0x7f4a7c15
  v_bfe_u32 v2, v1, 2, 2
  v_lshlrev_b32 v2, 7, v2
  v_lshrrev_b32 v3, 4, v1
  v_lshl_add_u32 v2, v3, 5, v2
  v_and_b32 v3, 3, v1
  v_lshl_add_u32 v2, v3, 3, v2
  v_add_u32 v2, 65536, v2
  v_lshlrev_b32 v6, 7, v1
  v_and_b32 v7, 7, v1
  v_lshl_add_u32 v6, v7, 4, v6
  v_add_u32 v6, 65536, v6
  v_lshlrev_b32 v4, 4, v1
  v_add_u32 v4, 65536, v4
  s_waitcnt vmcnt(0)
  ds_read_b64_tr_b16 v[20:21], v2 offset:0
  ds_read_b64_tr_b16 v[22:23], v2 offset:512
  ds_read_b64_tr_b16 v[24:25], v2 offset:1024
  ds_read_b64_tr_b16 v[26:27], v2 offset:1536
  ds_read_b64_tr_b16 v[28:29], v2 offset:2048
  ds_read_b64_tr_b16 v[30:31], v2 offset:2560
  ds_read_b64_tr_b16 v[32:33], v2 offset:3072
  ds_read_b64_tr_b16 v[34:35], v2 offset:3584
  ds_read_b64_tr_b16 v[36:37], v2 offset:4096
  ds_read_b64_tr_b16 v[38:39], v2 offset:4608
  ds_read_b64_tr_b16 v[40:41], v2 offset:5120
  ds_read_b64_tr_b16 v[42:43], v2 offset:5632
  s_waitcnt lgkmcnt(6)
  ds_read_b64_tr_b16 v[44:45], v2 offset:6144
  ds_read_b64_tr_b16 v[46:47], v2 offset:6656
  ds_read_b64_tr_b16 v[48:49], v2 offset:7168
  ds_read_b64_tr_b16 v[50:51], v2 offset:7680
  s_waitcnt lgkmcnt(0)
  v_xor_b32 v7, 0, v6
  ds_write_b128 v7, v[20:23]
  v_xor_b32 v7, 16, v6
  ds_write_b128 v7, v[24:27]
  v_xor_b32 v7, 32, v6
  ds_write_b128 v7, v[28:31]
  v_xor_b32 v7, 48, v6
  ds_write_b128 v7, v[32:35]
  v_xor_b32 v7, 64, v6
  ds_write_b128 v7, v[36:39]
  v_xor_b32 v7, 80, v6
  ds_write_b128 v7, v[40:43]
  v_xor_b32 v7, 96, v6
  ds_write_b128 v7, v[44:47]
  v_xor_b32 v7, 112, v6
  ds_write_b128 v7, v[48:51]
  s_waitcnt lgkmcnt(0)
  ds_read_b128 v[20:23], v4 offset:0
  ds_read_b128 v[24:27], v4 offset:1024
  ds_read_b128 v[28:31], v4 offset:2048
  ds_read_b128 v[32:35], v4 offset:3072
  ds_read_b128 v[36:39], v4 offset:4096
  ds_read_b128 v[40:43], v4 offset:5120
  ds_read_b128 v[44:47], v4 offset:6144
  ds_read_b128 v[48:51], v4 offset:7168
  v_mov_b32 v8, 163424
  v_mov_b32 v5, s66
  v_lshrrev_b32 v2, 3, v1
  v_and_b32 v3, 7, v1
  v_xor_b32 v3, v3, v2
  v_lshlrev_b32 v2, 12, v2
  v_lshl_add_u32 v2, v3, 4, v2
  s_lshl_b32 s70, s60, 18
  s_lshl_b32 s71, s61, 7
  s_add_u32 s70, s70, s71
  s_add_u32 s70, s70, 2097152
  s_waitcnt lgkmcnt(0)
  ds_write_b32 v8, v5
  buffer_store_dwordx4 v[20:23], v2, s[44:47], s70 offen sc1
  s_add_u32 s70, s70, 32768
  buffer_store_dwordx4 v[24:27], v2, s[44:47], s70 offen sc1
  s_add_u32 s70, s70, 32768
  buffer_store_dwordx4 v[28:31], v2, s[44:47], s70 offen sc1
  s_add_u32 s70, s70, 32768
  buffer_store_dwordx4 v[32:35], v2, s[44:47], s70 offen sc1
  s_add_u32 s70, s70, 32768
  buffer_store_dwordx4 v[36:39], v2, s[44:47], s70 offen sc1
  s_add_u32 s70, s70, 32768
  buffer_store_dwordx4 v[40:43], v2, s[44:47], s70 offen sc1
  s_add_u32 s70, s70, 32768
  buffer_store_dwordx4 v[44:47], v2, s[44:47], s70 offen sc1
  s_add_u32 s70, s70, 32768
  buffer_store_dwordx4 v[48:51], v2, s[44:47], s70 offen sc1
  s_add_u32 s70, s70, 32768
  s_lshl_b32 s70, s60, 11
  s_lshl_b32 s71, s61, 2
  s_add_u32 s70, s70, s71
  s_add_u32 s70, s70, 1049216
  v_lshlrev_b32 v2, 14, v1
  s_waitcnt vmcnt(0)
  s_mov_b32 exec_hi, 0x0
  buffer_store_dword v5, v2, s[44:47], s70 offen sc1
  s_mov_b64 exec, -1
L_gap1_join:
  s_setprio 0
  s_waitcnt lgkmcnt(0)
  s_barrier
  v_lshlrev_b32 v4, 4, v1
  s_and_b32 s70, s65, 7
  s_lshl_b32 s70, s70, 10
  s_add_u32 s70, s70, 73728
  v_add_u32 v2, s70, v4
  ds_read_b128 v[108:111], v2
  v_mov_b32 v7, 163520
  ds_read_b32 v7, v7
  s_waitcnt lgkmcnt(0)
  v_readfirstlane_b32 s67, v7
  s_barrier
  s_cmp_ge_u32 s65, 8
  s_cbranch_scc1 L_conv
  s_cmp_lt_u32 s65, 4
  s_cbranch_scc0 L_at_norf
  v_and_b32 v2, 1, v1
  v_lshlrev_b32 v2, 3, v2
  v_lshrrev_b32 v3, 1, v1
  v_add_u32 v2, v2, v3
  v_lshlrev_b32 v2, 11, v2
  v_mov_b32 v3, s66
  s_setprio 3
  s_waitcnt vmcnt(0)
  s_mov_b64 exec, 0xffff
  buffer_store_dword v3, v2, s[44:47], s3 offen sc1
  s_mov_b64 exec, -1
  s_setprio 0
L_at_norf:
  v_lshlrev_b32 v4, 4, v1
  v_lshlrev_b32 v5, 2, v1
  s_add_u32 s70, s86, 0
  v_add_u32 v5, s70, v5
  v_add_u32 v8, 0, v4
  ds_read_b128 v[72:75], v8
  s_lshl_b32 s70, s60, 3
  s_lshl_b64 s[6:7], 0xff, s70
  v_lshrrev_b32 v2, 5, v1
  v_lshlrev_b32 v2, 8, v2
  v_and_b32 v3, 15, v1
  v_lshl_add_u32 v2, v3, 4, v2
  v_add_u32 v9, 65536, v2
  v_and_b32 v2, 27, v1
  v_cmp_eq_u32 vcc, 16, v2
  v_mov_b32 v3, 0x3f803f80
  s_nop 0
  v_cndmask_b32 v2, 0, v3, vcc
  v_mov_b32 v80, v2
  v_mov_b32 v81, v2
  v_mov_b32 v82, v2
  v_mov_b32 v83, v2
  v_mov_b32 v84, v2
  v_mov_b32 v85, v2
  v_mov_b32 v86, v2
  v_mov_b32 v87, v2
  v_mov_b32 v88, v2
  v_mov_b32 v89, v2
  v_mov_b32 v90, v2
  v_mov_b32 v91, v2
  v_mov_b32 v92, v2
  v_mov_b32 v93, v2
  v_mov_b32 v94, v2
  v_mov_b32 v95, v2
  s_mov_b64 exec, s[78:79]
  ds_read_b128 v[80:83], v9
  ds_read_b128 v[84:87], v9 offset:512
  s_mov_b64 exec, -1
  v_mov_b32 v16, 0
  v_mov_b32 v17, 0
  v_mov_b32 v18, 0
  v_mov_b32 v19, 0
  v_mov_b32 v20, 0
  v_mov_b32 v21, 0
  v_mov_b32 v22, 0
  v_mov_b32 v23, 0
  v_mov_b32 v24, 0
  v_mov_b32 v25, 0
  v_mov_b32 v26, 0
  v_mov_b32 v27, 0
  v_mov_b32 v28, 0
  v_mov_b32 v29, 0
  v_mov_b32 v30, 0
  v_mov_b32 v31, 0
  v_mov_b32 v64, 0
  v_mov_b32 v65, 0
  v_mov_b32 v66, 0
  v_mov_b32 v67, 0
  v_mov_b32 v68, 0
  v_mov_b32 v69, 0
  v_mov_b32 v70, 0
  v_mov_b32 v71, 0
  s_waitcnt lgkmcnt(2)
  v_mfma_f32_32x32x16_bf16 v[32:47], v[72:75], v[108:111], 0
  s_nop 7
  s_nop 3
  ds_read_b128 v[76:79], v8 offset:1024
  v_exp_f32 v32, v32
  v_exp_f32 v33, v33
  v_exp_f32 v34, v34
  v_cvt_pk_bf16_f32 v64, v32, v33
  v_exp_f32 v35, v35
  v_mfma_f32_32x32x16_bf16 v[16:31], v[92:95], v[68:71], v[16:31]
  s_mov_b64 exec, s[78:79]
  ds_read_b128 v[88:91], v9 offset:1024
  ds_read_b128 v[92:95], v9 offset:1536
  s_mov_b64 exec, -1
  v_exp_f32 v36, v36
  v_cvt_pk_bf16_f32 v65, v34, v35
  v_exp_f32 v37, v37
  v_exp_f32 v38, v38
  v_cvt_pk_bf16_f32 v66, v36, v37
  s_waitcnt lgkmcnt(2)
  v_mfma_f32_32x32x16_bf16 v[48:63], v[76:79], v[108:111], 0
  v_exp_f32 v39, v39
  v_exp_f32 v40, v40
  v_cvt_pk_bf16_f32 v67, v38, v39
  v_exp_f32 v41, v41
  v_exp_f32 v42, v42
  v_mfma_f32_32x32x16_bf16 v[16:31], v[80:83], v[64:67], v[16:31]
  v_cvt_pk_bf16_f32 v68, v40, v41
  v_exp_f32 v43, v43
  v_exp_f32 v44, v44
  v_cvt_pk_bf16_f32 v69, v42, v43
  v_exp_f32 v45, v45
  v_exp_f32 v46, v46
  v_exp_f32 v47, v47
  v_cvt_pk_bf16_f32 v70, v44, v45
  v_cvt_pk_bf16_f32 v71, v46, v47
  ds_read_b128 v[72:75], v8 offset:2048
  v_exp_f32 v48, v48
  v_exp_f32 v49, v49
  v_exp_f32 v50, v50
  v_cvt_pk_bf16_f32 v64, v48, v49
  v_exp_f32 v51, v51
  v_mfma_f32_32x32x16_bf16 v[16:31], v[84:87], v[68:71], v[16:31]
  s_mov_b64 exec, s[78:79]
  ds_read_b128 v[80:83], v9 offset:2048
  ds_read_b128 v[84:87], v9 offset:2560
  s_mov_b64 exec, -1
  v_exp_f32 v52, v52
  v_cvt_pk_bf16_f32 v65, v50, v51
  v_exp_f32 v53, v53
  v_exp_f32 v54, v54
  v_cvt_pk_bf16_f32 v66, v52, v53
  s_waitcnt lgkmcnt(2)
  v_mfma_f32_32x32x16_bf16 v[32:47], v[72:75], v[108:111], 0
  v_exp_f32 v55, v55
  v_exp_f32 v56, v56
  v_cvt_pk_bf16_f32 v67, v54, v55
  v_exp_f32 v57, v57
  v_exp_f32 v58, v58
  v_mfma_f32_32x32x16_bf16 v[16:31], v[88:91], v[64:67], v[16:31]
  s_and_b32 s70, s65, 12
  s_cmp_eq_u32 s70, 4
  s_cbranch_scc0 L_at_d0
  s_mov_b32 s84, 0
L_rem_23:
  s_waitcnt vmcnt(0)
  v_cmp_ne_u32 vcc, s66, v6
  s_add_u32 s84, s84, 1
  s_nop 0
  s_andn2_b64 vcc, vcc, s[6:7]
  s_cbranch_scc0 L_rem_ok_24
  s_cmp_gt_u32 s84, 400000
  s_cbranch_scc1 L_rem_ok_24
  buffer_load_dword v6, v5, s[44:47], 0 offen sc1
  s_branch L_rem_23
L_rem_ok_24:
  s_add_u32 s70, s5, 2
  s_and_b32 s70, s70, 15
  s_lshl_b32 s70, s70, 12
  s_add_u32 s70, s70, s35
  s_add_u32 m0, s4, 8192
  s_add_u32 s74, s70, 4194304
  buffer_load_dwordx4 v4, s[44:47], s74 offen sc1 lds
  s_add_u32 m0, s4, 73728
  s_add_u32 s74, s70, 6291456
  buffer_load_dwordx4 v4, s[44:47], s74 offen sc1 lds
  s_add_u32 s70, s5, 3
  s_and_b32 s70, s70, 15
  s_lshl_b32 s70, s70, 12
  s_add_u32 s70, s70, s35
  s_add_u32 m0, s4, 12288
  s_add_u32 s74, s70, 4194304
  buffer_load_dwordx4 v4, s[44:47], s74 offen sc1 lds
  s_add_u32 m0, s4, 77824
  s_add_u32 s74, s70, 6291456
  buffer_load_dwordx4 v4, s[44:47], s74 offen sc1 lds
L_at_d0:
  v_cvt_pk_bf16_f32 v68, v56, v57
  v_exp_f32 v59, v59
  v_exp_f32 v60, v60
  v_cvt_pk_bf16_f32 v69, v58, v59
  v_exp_f32 v61, v61
  v_exp_f32 v62, v62
  v_exp_f32 v63, v63
  v_cvt_pk_bf16_f32 v70, v60, v61
  v_cvt_pk_bf16_f32 v71, v62, v63
  ds_read_b128 v[76:79], v8 offset:3072
  v_exp_f32 v32, v32
  v_exp_f32 v33, v33
  v_exp_f32 v34, v34
  v_cvt_pk_bf16_f32 v64, v32, v33
  v_exp_f32 v35, v35
  v_mfma_f32_32x32x16_bf16 v[16:31], v[92:95], v[68:71], v[16:31]
  s_mov_b64 exec, s[78:79]
  ds_read_b128 v[88:91], v9 offset:3072
  ds_read_b128 v[92:95], v9 offset:3584
  s_mov_b64 exec, -1
  v_exp_f32 v36, v36
  v_cvt_pk_bf16_f32 v65, v34, v35
  v_exp_f32 v37, v37
  v_exp_f32 v38, v38
  v_cvt_pk_bf16_f32 v66, v36, v37
  s_waitcnt lgkmcnt(2)
  v_mfma_f32_32x32x16_bf16 v[48:63], v[76:79], v[108:111], 0
  v_exp_f32 v39, v39
  v_exp_f32 v40, v40
  v_cvt_pk_bf16_f32 v67, v38, v39
  v_exp_f32 v41, v41
  v_exp_f32 v42, v42
  v_mfma_f32_32x32x16_bf16 v[16:31], v[80:83], v[64:67], v[16:31]
  s_and_b32 s70, s65, 12
  s_cmp_eq_u32 s70, 4
  s_cbranch_scc0 L_at_d1
  s_add_u32 s70, s5, 4
  s_and_b32 s70, s70, 15
  s_lshl_b32 s70, s70, 12
  s_add_u32 s70, s70, s35
  s_add_u32 m0, s4, 16384
  s_add_u32 s74, s70, 4194304
  buffer_load_dwordx4 v4, s[44:47], s74 offen sc1 lds
  s_add_u32 m0, s4, 81920
  s_add_u32 s74, s70, 6291456
  buffer_load_dwordx4 v4, s[44:47], s74 offen sc1 lds
  s_add_u32 s70, s5, 5
  s_and_b32 s70, s70, 15
  s_lshl_b32 s70, s70, 12
  s_add_u32 s70, s70, s35
  s_add_u32 m0, s4, 20480
  s_add_u32 s74, s70, 4194304
  buffer_load_dwordx4 v4, s[44:47], s74 offen sc1 lds
  s_add_u32 m0, s4, 86016
  s_add_u32 s74, s70, 6291456
  buffer_load_dwordx4 v4, s[44:47], s74 offen sc1 lds
L_at_d1:
  v_cvt_pk_bf16_f32 v68, v40, v41
  v_exp_f32 v43, v43
  v_exp_f32 v44, v44
  v_cvt_pk_bf16_f32 v69, v42, v43
  v_exp_f32 v45, v45
  v_exp_f32 v46, v46
  v_exp_f32 v47, v47
  v_cvt_pk_bf16_f32 v70, v44, v45
  v_cvt_pk_bf16_f32 v71, v46, v47
  ds_read_b128 v[72:75], v8 offset:4096
  v_exp_f32 v48, v48
  v_exp_f32 v49, v49
  v_exp_f32 v50, v50
  v_cvt_pk_bf16_f32 v64, v48, v49
  v_exp_f32 v51, v51
  v_mfma_f32_32x32x16_bf16 v[16:31], v[84:87], v[68:71], v[16:31]
  s_mov_b64 exec, s[78:79]
  ds_read_b128 v[80:83], v9 offset:4096
  ds_read_b128 v[84:87], v9 offset:4608
  s_mov_b64 exec, -1
  v_exp_f32 v52, v52
  v_cvt_pk_bf16_f32 v65, v50, v51
  v_exp_f32 v53, v53
  v_exp_f32 v54, v54
  v_cvt_pk_bf16_f32 v66, v52, v53
  s_waitcnt lgkmcnt(2)
  v_mfma_f32_32x32x16_bf16 v[32:47], v[72:75], v[108:111], 0
  v_exp_f32 v55, v55
  v_exp_f32 v56, v56
  v_cvt_pk_bf16_f32 v67, v54, v55
  v_exp_f32 v57, v57
  v_exp_f32 v58, v58
  v_mfma_f32_32x32x16_bf16 v[16:31], v[88:91], v[64:67], v[16:31]
  s_and_b32 s70, s65, 12
  s_cmp_eq_u32 s70, 4
  s_cbranch_scc0 L_at_d2
  s_add_u32 s70, s5, 6
  s_and_b32 s70, s70, 15
  s_lshl_b32 s70, s70, 12
  s_add_u32 s70, s70, s35
  s_add_u32 m0, s4, 24576
  s_add_u32 s74, s70, 4194304
  buffer_load_dwordx4 v4, s[44:47], s74 offen sc1 lds
  s_add_u32 m0, s4, 90112
  s_add_u32 s74, s70, 6291456
  buffer_load_dwordx4 v4, s[44:47], s74 offen sc1 lds
  s_add_u32 s70, s5, 7
  s_and_b32 s70, s70, 15
  s_lshl_b32 s70, s70, 12
  s_add_u32 s70, s70, s35
  s_add_u32 m0, s4, 28672
  s_add_u32 s74, s70, 4194304
  buffer_load_dwordx4 v4, s[44:47], s74 offen sc1 lds
  s_add_u32 m0, s4, 94208
  s_add_u32 s74, s70, 6291456
  buffer_load_dwordx4 v4, s[44:47], s74 offen sc1 lds
L_at_d2:
  v_cvt_pk_bf16_f32 v68, v56, v57
  v_exp_f32 v59, v59
  v_exp_f32 v60, v60
  v_cvt_pk_bf16_f32 v69, v58, v59
  v_exp_f32 v61, v61
  v_exp_f32 v62, v62
  v_exp_f32 v63, v63
  v_cvt_pk_bf16_f32 v70, v60, v61
  v_cvt_pk_bf16_f32 v71, v62, v63
  ds_read_b128 v[76:79], v8 offset:5120
  v_exp_f32 v32, v32
  v_exp_f32 v33, v33
  v_exp_f32 v34, v34
  v_cvt_pk_bf16_f32 v64, v32, v33
  v_exp_f32 v35, v35
  v_mfma_f32_32x32x16_bf16 v[16:31], v[92:95], v[68:71], v[16:31]
  s_mov_b64 exec, s[78:79]
  ds_read_b128 v[88:91], v9 offset:5120
  ds_read_b128 v[92:95], v9 offset:5632
  s_mov_b64 exec, -1
  v_exp_f32 v36, v36
  v_cvt_pk_bf16_f32 v65, v34, v35
  v_exp_f32 v37, v37
  v_exp_f32 v38, v38
  v_cvt_pk_bf16_f32 v66, v36, v37
  s_waitcnt lgkmcnt(2)
  v_mfma_f32_32x32x16_bf16 v[48:63], v[76:79], v[108:111], 0
  v_exp_f32 v39, v39
  v_exp_f32 v40, v40
  v_cvt_pk_bf16_f32 v67, v38, v39
  v_exp_f32 v41, v41
  v_exp_f32 v42, v42
  v_mfma_f32_32x32x16_bf16 v[16:31], v[80:83], v[64:67], v[16:31]
  v_cvt_pk_bf16_f32 v68, v40, v41
  v_exp_f32 v43, v43
  v_exp_f32 v44, v44
  v_cvt_pk_bf16_f32 v69, v42, v43
  v_exp_f32 v45, v45
  v_exp_f32 v46, v46
  v_exp_f32 v47, v47
  v_cvt_pk_bf16_f32 v70, v44, v45
  v_cvt_pk_bf16_f32 v71, v46, v47
  ds_read_b128 v[72:75], v8 offset:6144
  v_exp_f32 v48, v48
  v_exp_f32 v49, v49
  v_exp_f32 v50, v50
  v_cvt_pk_bf16_f32 v64, v48, v49
  v_exp_f32 v51, v51
  v_mfma_f32_32x32x16_bf16 v[16:31], v[84:87], v[68:71], v[16:31]
  s_mov_b64 exec, s[78:79]
  ds_read_b128 v[80:83], v9 offset:6144
  ds_read_b128 v[84:87], v9 offset:6656
  s_mov_b64 exec, -1
  v_exp_f32 v52, v52
  v_cvt_pk_bf16_f32 v65, v50, v51
  v_exp_f32 v53, v53
  v_exp_f32 v54, v54
  v_cvt_pk_bf16_f32 v66, v52, v53
  s_waitcnt lgkmcnt(2)
  v_mfma_f32_32x32x16_bf16 v[32:47], v[72:75], v[108:111], 0
  v_exp_f32 v55, v55
  v_exp_f32 v56, v56
  v_cvt_pk_bf16_f32 v67, v54, v55
  v_exp_f32 v57, v57
  v_exp_f32 v58, v58
  v_mfma_f32_32x32x16_bf16 v[16:31], v[88:91], v[64:67], v[16:31]
  v_cvt_pk_bf16_f32 v68, v56, v57
  v_exp_f32 v59, v59
  v_exp_f32 v60, v60
  v_cvt_pk_bf16_f32 v69, v58, v59
  v_exp_f32 v61, v61
  v_exp_f32 v62, v62
  v_exp_f32 v63, v63
  v_cvt_pk_bf16_f32 v70, v60, v61
  v_cvt_pk_bf16_f32 v71, v62, v63
  ds_read_b128 v[76:79], v8 offset:7168
  v_exp_f32 v32, v32
  v_exp_f32 v33, v33
  v_exp_f32 v34, v34
  v_cvt_pk_bf16_f32 v64, v32, v33
  v_exp_f32 v35, v35
  v_mfma_f32_32x32x16_bf16 v[16:31], v[92:95], v[68:71], v[16:31]
  s_mov_b64 exec, s[78:79]
  ds_read_b128 v[88:91], v9 offset:7168
  ds_read_b128 v[92:95], v9 offset:7680
  s_mov_b64 exec, -1
  v_exp_f32 v36, v36
  v_cvt_pk_bf16_f32 v65, v34, v35
  v_exp_f32 v37, v37
  v_exp_f32 v38, v38
  v_cvt_pk_bf16_f32 v66, v36, v37
  s_waitcnt lgkmcnt(2)
  v_mfma_f32_32x32x16_bf16 v[48:63], v[76:79], v[108:111], 0
  v_exp_f32 v39, v39
  v_exp_f32 v40, v40
  v_cvt_pk_bf16_f32 v67, v38, v39
  v_exp_f32 v41, v41
  v_exp_f32 v42, v42
  v_mfma_f32_32x32x16_bf16 v[16:31], v[80:83], v[64:67], v[16:31]
  v_cvt_pk_bf16_f32 v68, v40, v41
  v_exp_f32 v43, v43
  v_exp_f32 v44, v44
  v_cvt_pk_bf16_f32 v69, v42, v43
  v_exp_f32 v45, v45
  v_exp_f32 v46, v46
  v_exp_f32 v47, v47
  v_cvt_pk_bf16_f32 v70, v44, v45
  v_cvt_pk_bf16_f32 v71, v46, v47
  s_waitcnt vmcnt(0)
  s_barrier
  ds_read_b128 v[72:75], v8 offset:8192
  v_exp_f32 v48, v48
  v_exp_f32 v49, v49
  v_exp_f32 v50, v50
  v_cvt_pk_bf16_f32 v64, v48, v49
  v_exp_f32 v51, v51
  v_mfma_f32_32x32x16_bf16 v[16:31], v[84:87], v[68:71], v[16:31]
  s_mov_b64 exec, s[78:79]
  ds_read_b128 v[80:83], v9 offset:8192
  ds_read_b128 v[84:87], v9 offset:8704
  s_mov_b64 exec, -1
  v_exp_f32 v52, v52
  v_cvt_pk_bf16_f32 v65, v50, v51
  v_exp_f32 v53, v53
  v_exp_f32 v54, v54
  v_cvt_pk_bf16_f32 v66, v52, v53
  s_waitcnt lgkmcnt(2)
  v_mfma_f32_32x32x16_bf16 v[32:47], v[72:75], v[108:111], 0
  v_exp_f32 v55, v55
  v_exp_f32 v56, v56
  v_cvt_pk_bf16_f32 v67, v54, v55
  v_exp_f32 v57, v57
  v_exp_f32 v58, v58
  v_mfma_f32_32x32x16_bf16 v[16:31], v[88:91], v[64:67], v[16:31]
  v_cvt_pk_bf16_f32 v68, v56, v57
  v_exp_f32 v59, v59
  v_exp_f32 v60, v60
  v_cvt_pk_bf16_f32 v69, v58, v59
  v_exp_f32 v61, v61
  v_exp_f32 v62, v62
  v_exp_f32 v63, v63
  v_cvt_pk_bf16_f32 v70, v60, v61
  v_cvt_pk_bf16_f32 v71, v62, v63
  v_add_u32 v8, 8192, v8
  v_add_u32 v9, 8192, v9
L_at_shared:
  ds_read_b128 v[76:79], v8 offset:1024
  v_exp_f32 v32, v32
  v_exp_f32 v33, v33
  v_exp_f32 v34, v34
  v_cvt_pk_bf16_f32 v64, v32, v33
  v_exp_f32 v35, v35
  v_mfma_f32_32x32x16_bf16 v[16:31], v[92:95], v[68:71], v[16:31]
  s_mov_b64 exec, s[78:79]
  ds_read_b128 v[88:91], v9 offset:1024
  ds_read_b128 v[92:95], v9 offset:1536
  s_mov_b64 exec, -1
  v_exp_f32 v36, v36
  v_cvt_pk_bf16_f32 v65, v34, v35
  v_exp_f32 v37, v37
  v_exp_f32 v38, v38
  v_cvt_pk_bf16_f32 v66, v36, v37
  s_waitcnt lgkmcnt(2)
  v_mfma_f32_32x32x16_bf16 v[48:63], v[76:79], v[108:111], 0
  v_exp_f32 v39, v39
  v_exp_f32 v40, v40
  v_cvt_pk_bf16_f32 v67, v38, v39
  v_exp_f32 v41, v41
  v_exp_f32 v42, v42
  v_mfma_f32_32x32x16_bf16 v[16:31], v[80:83], v[64:67], v[16:31]
  s_and_b32 s70, s65, 12
  s_cmp_eq_u32 s70, 4
  s_cbranch_scc0 L_at_d3
  s_add_u32 s70, s5, 8
  s_and_b32 s70, s70, 15
  s_lshl_b32 s70, s70, 12
  s_add_u32 s70, s70, s35
  s_add_u32 m0, s4, 32768
  s_add_u32 s74, s70, 4194304
  buffer_load_dwordx4 v4, s[44:47], s74 offen sc1 lds
  s_add_u32 m0, s4, 98304
  s_add_u32 s74, s70, 6291456
  buffer_load_dwordx4 v4, s[44:47], s74 offen sc1 lds
  s_add_u32 s70, s5, 9
  s_and_b32 s70, s70, 15
  s_lshl_b32 s70, s70, 12
  s_add_u32 s70, s70, s35
  s_add_u32 m0, s4, 36864
  s_add_u32 s74, s70, 4194304
  buffer_load_dwordx4 v4, s[44:47], s74 offen sc1 lds
  s_add_u32 m0, s4, 102400
  s_add_u32 s74, s70, 6291456
  buffer_load_dwordx4 v4, s[44:47], s74 offen sc1 lds
L_at_d3:
  s_cmp_ge_u32 s65, 8
  s_cbranch_scc0 L_at_noyf
  v_lshlrev_b32 v2, 14, v1
  v_mov_b32 v3, s66
  s_waitcnt vmcnt(0)
  s_mov_b64 exec, 0xff
  s_cmp_eq_u32 s67, 0
  s_cbranch_scc1 L_wt_25
  buffer_store_dword v3, v2, s[44:47], s3 offen
  s_branch L_std_26
L_wt_25:
  buffer_store_dword v3, v2, s[44:47], s3 offen sc1
L_std_26:
  s_mov_b64 exec, -1
L_at_noyf:
  v_cvt_pk_bf16_f32 v68, v40, v41
  v_exp_f32 v43, v43
  v_exp_f32 v44, v44
  v_cvt_pk_bf16_f32 v69, v42, v43
  v_exp_f32 v45, v45
  v_exp_f32 v46, v46
  v_exp_f32 v47, v47
  v_cvt_pk_bf16_f32 v70, v44, v45
  v_cvt_pk_bf16_f32 v71, v46, v47
  ds_read_b128 v[72:75], v8 offset:4096
  v_exp_f32 v48, v48
  v_exp_f32 v49, v49
  v_exp_f32 v50, v50
  v_cvt_pk_bf16_f32 v64, v48, v49
  v_exp_f32 v51, v51
  v_mfma_f32_32x32x16_bf16 v[16:31], v[84:87], v[68:71], v[16:31]
  s_mov_b64 exec, s[78:79]
  ds_read_b128 v[80:83], v9 offset:4096
  ds_read_b128 v[84:87], v9 offset:4608
  s_mov_b64 exec, -1
  v_exp_f32 v52, v52
  v_cvt_pk_bf16_f32 v65, v50, v51
  v_exp_f32 v53, v53
  v_exp_f32 v54, v54
  v_cvt_pk_bf16_f32 v66, v52, v53
  s_waitcnt lgkmcnt(2)
  v_mfma_f32_32x32x16_bf16 v[32:47], v[72:75], v[108:111], 0
  v_exp_f32 v55, v55
  v_exp_f32 v56, v56
  v_cvt_pk_bf16_f32 v67, v54, v55
  v_exp_f32 v57, v57
  v_exp_f32 v58, v58
  v_mfma_f32_32x32x16_bf16 v[16:31], v[88:91], v[64:67], v[16:31]
  s_and_b32 s70, s65, 12
  s_cmp_eq_u32 s70, 4
  s_cbranch_scc0 L_at_d4
  s_add_u32 s70, s5, 10
  s_and_b32 s70, s70, 15
  s_lshl_b32 s70, s70, 12
  s_add_u32 s70, s70, s35
  s_add_u32 m0, s4, 40960
  s_add_u32 s74, s70, 4194304
  buffer_load_dwordx4 v4, s[44:47], s74 offen sc1 lds
  s_add_u32 m0, s4, 106496
  s_add_u32 s74, s70, 6291456
  buffer_load_dwordx4 v4, s[44:47], s74 offen sc1 lds
  s_add_u32 s70, s5, 11
  s_and_b32 s70, s70, 15
  s_lshl_b32 s70, s70, 12
  s_add_u32 s70, s70, s35
  s_add_u32 m0, s4, 45056
  s_add_u32 s74, s70, 4194304
  buffer_load_dwordx4 v4, s[44:47], s74 offen sc1 lds
  s_add_u32 m0, s4, 110592
  s_add_u32 s74, s70, 6291456
  buffer_load_dwordx4 v4, s[44:47], s74 offen sc1 lds
L_at_d4:
  v_cvt_pk_bf16_f32 v68, v56, v57
  v_exp_f32 v59, v59
  v_exp_f32 v60, v60
  v_cvt_pk_bf16_f32 v69, v58, v59
  v_exp_f32 v61, v61
  v_exp_f32 v62, v62
  v_exp_f32 v63, v63
  v_cvt_pk_bf16_f32 v70, v60, v61
  v_cvt_pk_bf16_f32 v71, v62, v63
  ds_read_b128 v[76:79], v8 offset:5120
  v_exp_f32 v32, v32
  v_exp_f32 v33, v33
  v_exp_f32 v34, v34
  v_cvt_pk_bf16_f32 v64, v32, v33
  v_exp_f32 v35, v35
  v_mfma_f32_32x32x16_bf16 v[16:31], v[92:95], v[68:71], v[16:31]
  s_mov_b64 exec, s[78:79]
  ds_read_b128 v[88:91], v9 offset:5120
  ds_read_b128 v[92:95], v9 offset:5632
  s_mov_b64 exec, -1
  v_exp_f32 v36, v36
  v_cvt_pk_bf16_f32 v65, v34, v35
  v_exp_f32 v37, v37
  v_exp_f32 v38, v38
  v_cvt_pk_bf16_f32 v66, v36, v37
  s_waitcnt lgkmcnt(2)
  v_mfma_f32_32x32x16_bf16 v[48:63], v[76:79], v[108:111], 0
  v_exp_f32 v39, v39
  v_exp_f32 v40, v40
  v_cvt_pk_bf16_f32 v67, v38, v39
  v_exp_f32 v41, v41
  v_exp_f32 v42, v42
  v_mfma_f32_32x32x16_bf16 v[16:31], v[80:83], v[64:67], v[16:31]
  s_and_b32 s70, s65, 12
  s_cmp_eq_u32 s70, 4
  s_cbranch_scc0 L_at_d5
  s_add_u32 s70, s5, 12
  s_and_b32 s70, s70, 15
  s_lshl_b32 s70, s70, 12
  s_add_u32 s70, s70, s35
  s_add_u32 m0, s4, 49152
  s_add_u32 s74, s70, 4194304
  buffer_load_dwordx4 v4, s[44:47], s74 offen sc1 lds
  s_add_u32 m0, s4, 114688
  s_add_u32 s74, s70, 6291456
  buffer_load_dwordx4 v4, s[44:47], s74 offen sc1 lds
  s_add_u32 s70, s5, 13
  s_and_b32 s70, s70, 15
  s_lshl_b32 s70, s70, 12
  s_add_u32 s70, s70, s35
  s_add_u32 m0, s4, 53248
  s_add_u32 s74, s70, 4194304
  buffer_load_dwordx4 v4, s[44:47], s74 offen sc1 lds
  s_add_u32 m0, s4, 118784
  s_add_u32 s74, s70, 6291456
  buffer_load_dwordx4 v4, s[44:47], s74 offen sc1 lds
L_at_d5:
  v_cvt_pk_bf16_f32 v68, v40, v41
  v_exp_f32 v43, v43
  v_exp_f32 v44, v44
  v_cvt_pk_bf16_f32 v69, v42, v43
  v_exp_f32 v45, v45
  v_exp_f32 v46, v46
  v_exp_f32 v47, v47
  v_cvt_pk_bf16_f32 v70, v44, v45
  v_cvt_pk_bf16_f32 v71, v46, v47
  ds_read_b128 v[72:75], v8 offset:8192
  v_exp_f32 v48, v48
  v_exp_f32 v49, v49
  v_exp_f32 v50, v50
  v_cvt_pk_bf16_f32 v64, v48, v49
  v_exp_f32 v51, v51
  v_mfma_f32_32x32x16_bf16 v[16:31], v[84:87], v[68:71], v[16:31]
  s_mov_b64 exec, s[78:79]
  ds_read_b128 v[80:83], v9 offset:8192
  ds_read_b128 v[84:87], v9 offset:8704
  s_mov_b64 exec, -1
  v_exp_f32 v52, v52
  v_cvt_pk_bf16_f32 v65, v50, v51
  v_exp_f32 v53, v53
  v_exp_f32 v54, v54
  v_cvt_pk_bf16_f32 v66, v52, v53
  s_waitcnt lgkmcnt(2)
  v_mfma_f32_32x32x16_bf16 v[32:47], v[72:75], v[108:111], 0
  v_exp_f32 v55, v55
  v_exp_f32 v56, v56
  v_cvt_pk_bf16_f32 v67, v54, v55
  v_exp_f32 v57, v57
  v_exp_f32 v58, v58
  v_mfma_f32_32x32x16_bf16 v[16:31], v[88:91], v[64:67], v[16:31]
  s_and_b32 s70, s65, 12
  s_cmp_eq_u32 s70, 4
  s_cbranch_scc0 L_at_d6
  s_add_u32 s70, s5, 14
  s_and_b32 s70, s70, 15
  s_lshl_b32 s70, s70, 12
  s_add_u32 s70, s70, s35
  s_add_u32 m0, s4, 57344
  s_add_u32 s74, s70, 4194304
  buffer_load_dwordx4 v4, s[44:47], s74 offen sc1 lds
  s_add_u32 m0, s4, 122880
  s_add_u32 s74, s70, 6291456
  buffer_load_dwordx4 v4, s[44:47], s74 offen sc1 lds
  s_add_u32 s70, s5, 15
  s_and_b32 s70, s70, 15
  s_lshl_b32 s70, s70, 12
  s_add_u32 s70, s70, s35
  s_add_u32 m0, s4, 61440
  s_add_u32 s74, s70, 4194304
  buffer_load_dwordx4 v4, s[44:47], s74 offen sc1 lds
  s_add_u32 m0, s4, 126976
  s_add_u32 s74, s70, 6291456
  buffer_load_dwordx4 v4, s[44:47], s74 offen sc1 lds
L_at_d6:
  v_cvt_pk_bf16_f32 v68, v56, v57
  v_exp_f32 v59, v59
  v_exp_f32 v60, v60
  v_cvt_pk_bf16_f32 v69, v58, v59
  v_exp_f32 v61, v61
  v_exp_f32 v62, v62
  v_exp_f32 v63, v63
  v_cvt_pk_bf16_f32 v70, v60, v61
  v_cvt_pk_bf16_f32 v71, v62, v63
  v_add_u32 v8, 8192, v8
  v_add_u32 v9, 8192, v9
  s_mov_b32 s34, 1
.p2align 6
L_at_loop:
  s_cmp_ge_u32 s34, 2
  s_cbranch_scc1 L_at_hook
L_at_back:
  ds_read_b128 v[76:79], v8 offset:1024
  v_exp_f32 v32, v32
  v_exp_f32 v33, v33
  v_exp_f32 v34, v34
  v_cvt_pk_bf16_f32 v64, v32, v33
  v_exp_f32 v35, v35
  v_mfma_f32_32x32x16_bf16 v[16:31], v[92:95], v[68:71], v[16:31]
  s_mov_b64 exec, s[78:79]
  ds_read_b128 v[88:91], v9 offset:1024
  ds_read_b128 v[92:95], v9 offset:1536
  s_mov_b64 exec, -1
  v_exp_f32 v36, v36
  v_cvt_pk_bf16_f32 v65, v34, v35
  v_exp_f32 v37, v37
  v_exp_f32 v38, v38
  v_cvt_pk_bf16_f32 v66, v36, v37
  s_waitcnt lgkmcnt(2)
  v_mfma_f32_32x32x16_bf16 v[48:63], v[76:79], v[108:111], 0
  v_exp_f32 v39, v39
  v_exp_f32 v40, v40
  v_cvt_pk_bf16_f32 v67, v38, v39
  v_exp_f32 v41, v41
  v_exp_f32 v42, v42
  v_mfma_f32_32x32x16_bf16 v[16:31], v[80:83], v[64:67], v[16:31]
  v_cvt_pk_bf16_f32 v68, v40, v41
  v_exp_f32 v43, v43
  v_exp_f32 v44, v44
  v_cvt_pk_bf16_f32 v69, v42, v43
  v_exp_f32 v45, v45
  v_exp_f32 v46, v46
  v_exp_f32 v47, v47
  v_cvt_pk_bf16_f32 v70, v44, v45
  v_cvt_pk_bf16_f32 v71, v46, v47
  ds_read_b128 v[72:75], v8 offset:4096
  v_exp_f32 v48, v48
  v_exp_f32 v49, v49
  v_exp_f32 v50, v50
  v_cvt_pk_bf16_f32 v64, v48, v49
  v_exp_f32 v51, v51
  v_mfma_f32_32x32x16_bf16 v[16:31], v[84:87], v[68:71], v[16:31]
  s_mov_b64 exec, s[78:79]
  ds_read_b128 v[80:83], v9 offset:4096
  ds_read_b128 v[84:87], v9 offset:4608
  s_mov_b64 exec, -1
  v_exp_f32 v52, v52
  v_cvt_pk_bf16_f32 v65, v50, v51
  v_exp_f32 v53, v53
  v_exp_f32 v54, v54
  v_cvt_pk_bf16_f32 v66, v52, v53
  s_waitcnt lgkmcnt(2)
  v_mfma_f32_32x32x16_bf16 v[32:47], v[72:75], v[108:111], 0
  v_exp_f32 v55, v55
  v_exp_f32 v56, v56
  v_cvt_pk_bf16_f32 v67, v54, v55
  v_exp_f32 v57, v57
  v_exp_f32 v58, v58
  v_mfma_f32_32x32x16_bf16 v[16:31], v[88:91], v[64:67], v[16:31]
  v_cvt_pk_bf16_f32 v68, v56, v57
  v_exp_f32 v59, v59
  v_exp_f32 v60, v60
  v_cvt_pk_bf16_f32 v69, v58, v59
  v_exp_f32 v61, v61
  v_exp_f32 v62, v62
  v_exp_f32 v63, v63
  v_cvt_pk_bf16_f32 v70, v60, v61
  v_cvt_pk_bf16_f32 v71, v62, v63
  ds_read_b128 v[76:79], v8 offset:5120
  v_exp_f32 v32, v32
  v_exp_f32 v33, v33
  v_exp_f32 v34, v34
  v_cvt_pk_bf16_f32 v64, v32, v33
  v_exp_f32 v35, v35
  v_mfma_f32_32x32x16_bf16 v[16:31], v[92:95], v[68:71], v[16:31]
  s_mov_b64 exec, s[78:79]
  ds_read_b128 v[88:91], v9 offset:5120
  ds_read_b128 v[92:95], v9 offset:5632
  s_mov_b64 exec, -1
  v_exp_f32 v36, v36
  v_cvt_pk_bf16_f32 v65, v34, v35
  v_exp_f32 v37, v37
  v_exp_f32 v38, v38
  v_cvt_pk_bf16_f32 v66, v36, v37
  s_waitcnt lgkmcnt(2)
  v_mfma_f32_32x32x16_bf16 v[48:63], v[76:79], v[108:111], 0
  v_exp_f32 v39, v39
  v_exp_f32 v40, v40
  v_cvt_pk_bf16_f32 v67, v38, v39
  v_exp_f32 v41, v41
  v_exp_f32 v42, v42
  v_mfma_f32_32x32x16_bf16 v[16:31], v[80:83], v[64:67], v[16:31]
  v_cvt_pk_bf16_f32 v68, v40, v41
  v_exp_f32 v43, v43
  v_exp_f32 v44, v44
  v_cvt_pk_bf16_f32 v69, v42, v43
  v_exp_f32 v45, v45
  v_exp_f32 v46, v46
  v_exp_f32 v47, v47
  v_cvt_pk_bf16_f32 v70, v44, v45
  v_cvt_pk_bf16_f32 v71, v46, v47
  ds_read_b128 v[72:75], v8 offset:8192
  v_exp_f32 v48, v48
  v_exp_f32 v49, v49
  v_exp_f32 v50, v50
  v_cvt_pk_bf16_f32 v64, v48, v49
  v_exp_f32 v51, v51
  v_mfma_f32_32x32x16_bf16 v[16:31], v[84:87], v[68:71], v[16:31]
  s_mov_b64 exec, s[78:79]
  ds_read_b128 v[80:83], v9 offset:8192
  ds_read_b128 v[84:87], v9 offset:8704
  s_mov_b64 exec, -1
  v_exp_f32 v52, v52
  v_cvt_pk_bf16_f32 v65, v50, v51
  v_exp_f32 v53, v53
  v_exp_f32 v54, v54
  v_cvt_pk_bf16_f32 v66, v52, v53
  s_waitcnt lgkmcnt(2)
  v_mfma_f32_32x32x16_bf16 v[32:47], v[72:75], v[108:111], 0
  v_exp_f32 v55, v55
  v_exp_f32 v56, v56
  v_cvt_pk_bf16_f32 v67, v54, v55
  v_exp_f32 v57, v57
  v_exp_f32 v58, v58
  v_mfma_f32_32x32x16_bf16 v[16:31], v[88:91], v[64:67], v[16:31]
  v_cvt_pk_bf16_f32 v68, v56, v57
  v_exp_f32 v59, v59
  v_exp_f32 v60, v60
  v_cvt_pk_bf16_f32 v69, v58, v59
  v_exp_f32 v61, v61
  v_exp_f32 v62, v62
  v_exp_f32 v63, v63
  v_cvt_pk_bf16_f32 v70, v60, v61
  v_cvt_pk_bf16_f32 v71, v62, v63
  ds_read_b128 v[76:79], v8 offset:9216
  v_exp_f32 v32, v32
  v_exp_f32 v33, v33
  v_exp_f32 v34, v34
  v_cvt_pk_bf16_f32 v64, v32, v33
  v_exp_f32 v35, v35
  v_mfma_f32_32x32x16_bf16 v[16:31], v[92:95], v[68:71], v[16:31]
  s_mov_b64 exec, s[78:79]
  ds_read_b128 v[88:91], v9 offset:9216
  ds_read_b128 v[92:95], v9 offset:9728
  s_mov_b64 exec, -1
  v_exp_f32 v36, v36
  v_cvt_pk_bf16_f32 v65, v34, v35
  v_exp_f32 v37, v37
  v_exp_f32 v38, v38
  v_cvt_pk_bf16_f32 v66, v36, v37
  s_waitcnt lgkmcnt(2)
  v_mfma_f32_32x32x16_bf16 v[48:63], v[76:79], v[108:111], 0
  v_exp_f32 v39, v39
  v_exp_f32 v40, v40
  v_cvt_pk_bf16_f32 v67, v38, v39
  v_exp_f32 v41, v41
  v_exp_f32 v42, v42
  v_mfma_f32_32x32x16_bf16 v[16:31], v[80:83], v[64:67], v[16:31]
  v_cvt_pk_bf16_f32 v68, v40, v41
  v_exp_f32 v43, v43
  v_exp_f32 v44, v44
  v_cvt_pk_bf16_f32 v69, v42, v43
  v_exp_f32 v45, v45
  v_exp_f32 v46, v46
  v_exp_f32 v47, v47
  v_cvt_pk_bf16_f32 v70, v44, v45
  v_cvt_pk_bf16_f32 v71, v46, v47
  ds_read_b128 v[72:75], v8 offset:12288
  v_exp_f32 v48, v48
  v_exp_f32 v49, v49
  v_exp_f32 v50, v50
  v_cvt_pk_bf16_f32 v64, v48, v49
  v_exp_f32 v51, v51
  v_mfma_f32_32x32x16_bf16 v[16:31], v[84:87], v[68:71], v[16:31]
  s_mov_b64 exec, s[78:79]
  ds_read_b128 v[80:83], v9 offset:12288
  ds_read_b128 v[84:87], v9 offset:12800
  s_mov_b64 exec, -1
  v_exp_f32 v52, v52
  v_cvt_pk_bf16_f32 v65, v50, v51
  v_exp_f32 v53, v53
  v_exp_f32 v54, v54
  v_cvt_pk_bf16_f32 v66, v52, v53
  s_waitcnt lgkmcnt(2)
  v_mfma_f32_32x32x16_bf16 v[32:47], v[72:75], v[108:111], 0
  v_exp_f32 v55, v55
  v_exp_f32 v56, v56
  v_cvt_pk_bf16_f32 v67, v54, v55
  v_exp_f32 v57, v57
  v_exp_f32 v58, v58
  v_mfma_f32_32x32x16_bf16 v[16:31], v[88:91], v[64:67], v[16:31]
  v_cvt_pk_bf16_f32 v68, v56, v57
  v_exp_f32 v59, v59
  v_exp_f32 v60, v60
  v_cvt_pk_bf16_f32 v69, v58, v59
  v_exp_f32 v61, v61
  v_exp_f32 v62, v62
  v_exp_f32 v63, v63
  v_cvt_pk_bf16_f32 v70, v60, v61
  v_cvt_pk_bf16_f32 v71, v62, v63
  ds_read_b128 v[76:79], v8 offset:13312
  v_exp_f32 v32, v32
  v_exp_f32 v33, v33
  v_exp_f32 v34, v34
  v_cvt_pk_bf16_f32 v64, v32, v33
  v_exp_f32 v35, v35
  v_mfma_f32_32x32x16_bf16 v[16:31], v[92:95], v[68:71], v[16:31]
  s_mov_b64 exec, s[78:79]
  ds_read_b128 v[88:91], v9 offset:13312
  ds_read_b128 v[92:95], v9 offset:13824
  s_mov_b64 exec, -1
  v_exp_f32 v36, v36
  v_cvt_pk_bf16_f32 v65, v34, v35
  v_exp_f32 v37, v37
  v_exp_f32 v38, v38
  v_cvt_pk_bf16_f32 v66, v36, v37
  s_waitcnt lgkmcnt(2)
  v_mfma_f32_32x32x16_bf16 v[48:63], v[76:79], v[108:111], 0
  v_exp_f32 v39, v39
  v_exp_f32 v40, v40
  v_cvt_pk_bf16_f32 v67, v38, v39
  v_exp_f32 v41, v41
  v_exp_f32 v42, v42
  v_mfma_f32_32x32x16_bf16 v[16:31], v[80:83], v[64:67], v[16:31]
  v_cvt_pk_bf16_f32 v68, v40, v41
  v_exp_f32 v43, v43
  v_exp_f32 v44, v44
  v_cvt_pk_bf16_f32 v69, v42, v43
  v_exp_f32 v45, v45
  v_exp_f32 v46, v46
  v_exp_f32 v47, v47
  v_cvt_pk_bf16_f32 v70, v44, v45
  v_cvt_pk_bf16_f32 v71, v46, v47
  s_cmp_eq_u32 s34, 1
  s_cbranch_scc1 L_at_r2
L_at_r2back:
  ds_read_b128 v[72:75], v8 offset:16384
  v_exp_f32 v48, v48
  v_exp_f32 v49, v49
  v_exp_f32 v50, v50
  v_cvt_pk_bf16_f32 v64, v48, v49
  v_exp_f32 v51, v51
  v_mfma_f32_32x32x16_bf16 v[16:31], v[84:87], v[68:71], v[16:31]
  s_mov_b64 exec, s[78:79]
  ds_read_b128 v[80:83], v9 offset:16384
  ds_read_b128 v[84:87], v9 offset:16896
  s_mov_b64 exec, -1
  v_exp_f32 v52, v52
  v_cvt_pk_bf16_f32 v65, v50, v51
  v_exp_f32 v53, v53
  v_exp_f32 v54, v54
  v_cvt_pk_bf16_f32 v66, v52, v53
  s_waitcnt lgkmcnt(2)
  v_mfma_f32_32x32x16_bf16 v[32:47], v[72:75], v[108:111], 0
  v_exp_f32 v55, v55
  v_exp_f32 v56, v56
  v_cvt_pk_bf16_f32 v67, v54, v55
  v_exp_f32 v57, v57
  v_exp_f32 v58, v58
  v_mfma_f32_32x32x16_bf16 v[16:31], v[88:91], v[64:67], v[16:31]
  v_cvt_pk_bf16_f32 v68, v56, v57
  v_exp_f32 v59, v59
  v_exp_f32 v60, v60
  v_cvt_pk_bf16_f32 v69, v58, v59
  v_exp_f32 v61, v61
  v_exp_f32 v62, v62
  v_exp_f32 v63, v63
  v_cvt_pk_bf16_f32 v70, v60, v61
  v_cvt_pk_bf16_f32 v71, v62, v63
  v_add_u32 v8, 16384, v8
  v_add_u32 v9, 16384, v9
  s_add_u32 s34, s34, 1
  s_cmp_lt_u32 s34, 4
  s_cbranch_scc1 L_at_loop
  v_mfma_f32_32x32x16_bf16 v[16:31], v[92:95], v[68:71], v[16:31]
  s_waitcnt lgkmcnt(0)
  s_and_b32 s70, s65, 3
  s_mul_i32 s70, s70, 2304
  s_bfe_u32 s71, s65, 0x10002
  s_lshl_b32 s71, s71, 16
  s_add_u32 s70, s70, s71
  s_add_u32 s70, s70, 32768
  v_add_u32 v2, s70, v4
  v_lshlrev_b32 v3, 2, v1
  v_add_u32 v3, s70, v3
  s_cmp_lt_u32 s65, 8
  s_cbranch_scc1 L_at_recv
  s_nop 1
  ds_write_b128 v2, v[16:19]
  ds_write_b128 v2, v[20:23] offset:1024
  ds_write_b32 v3, v24 offset:2048
  s_waitcnt vmcnt(0) lgkmcnt(0)
  s_barrier
  s_branch L_e1
L_at_recv:
  s_waitcnt vmcnt(0)
  s_barrier
  ds_read_b128 v[32:35], v2
  ds_read_b128 v[36:39], v2 offset:1024
  ds_read_b32 v40, v3 offset:2048
  s_waitcnt lgkmcnt(0)
  v_add_f32 v16, v16, v32
  v_add_f32 v17, v17, v33
  v_add_f32 v18, v18, v34
  v_add_f32 v19, v19, v35
  v_add_f32 v20, v20, v36
  v_add_f32 v21, v21, v37
  v_add_f32 v22, v22, v38
  v_add_f32 v23, v23, v39
  v_add_f32 v24, v24, v40
  s_mov_b32 s34, 0
L_at_norm:
  v_rcp_f32 v2, v24
  s_mov_b32 s76, 0x2b800000
  s_mov_b32 s77, 0x71800000
  v_mul_f32 v64, v16, v2
  v_mul_f32 v65, v17, v2
  v_mul_f32 v66, v18, v2
  v_mul_f32 v67, v19, v2
  v_mul_f32 v68, v20, v2
  v_mul_f32 v69, v21, v2
  v_mul_f32 v70, v22, v2
  v_mul_f32 v71, v23, v2
  v_add_f32 v3, |v64|, |v65|
  v_add_f32 v3, v3, |v66|
  v_add_f32 v3, v3, |v67|
  v_add_f32 v3, v3, |v68|
  v_add_f32 v3, v3, |v69|
  v_add_f32 v3, v3, |v70|
  v_add_f32 v3, v3, |v71|
  v_cmp_nle_f32 vcc, s76, v24
  v_cmp_nge_f32 s[70:71], s77, v24
  v_cmp_nge_f32 s[72:73], s77, v3
  s_nop 1
  s_or_b64 vcc, vcc, s[70:71]
  s_or_b64 vcc, vcc, s[72:73]
  s_cmp_eq_u32 s34, 1
  s_cbranch_scc1 L_at_normok
  s_cbranch_vccnz L_at_fallback
L_at_normok:
  v_cvt_pk_bf16_f32 v64, v64, v65
  v_cvt_pk_bf16_f32 v65, v66, v67
  v_cvt_pk_bf16_f32 v66, v68, v69
  v_cvt_pk_bf16_f32 v67, v70, v71
  s_lshl_b32 s70, s60, 3
  s_add_u32 s70, s70, s65
  s_lshl_b32 s70, s70, 5
  s_add_u32 s70, s70, s68
  s_lshl_b32 s70, s70, 10
  s_add_u32 s70, s70, 14680064
  s_cmp_eq_u32 s67, 0
  s_cbranch_scc1 L_wt_27
  buffer_store_dwordx4 v[64:67], v4, s[44:47], s70 offen
  s_branch L_std_28
L_wt_27:
  buffer_store_dwordx4 v[64:67], v4, s[44:47], s70 offen sc1
L_std_28:
  s_lshr_b32 s70, s65, 1
  s_lshl_b32 s70, s70, 14
  s_lshl_b32 s71, s60, 11
  s_add_u32 s70, s70, s71
  s_lshl_b32 s71, s68, 3
  s_add_u32 s70, s70, s71
  s_and_b32 s71, s65, 1
  s_lshl_b32 s71, s71, 2
  s_add_u32 s70, s70, s71
  s_add_u32 s70, s70, 1049600
  v_lshlrev_b32 v6, 16, v1
  v_mov_b32 v7, s66
  s_waitcnt vmcnt(0)
  s_mov_b64 exec, 0xff
  s_cmp_eq_u32 s67, 0
  s_cbranch_scc1 L_wt_29
  buffer_store_dword v7, v6, s[44:47], s70 offen
  s_branch L_std_30
L_wt_29:
  buffer_store_dword v7, v6, s[44:47], s70 offen sc1
L_std_30:
  s_mov_b64 exec, -1
  s_cmp_eq_u32 s65, 0
  s_cbranch_scc0 L_e1
  v_lshlrev_b32 v2, 2, v1
  s_add_u32 s70, s86, 1024
  v_add_u32 v2, s70, v2
  s_mov_b32 s84, 0
  buffer_load_dword v3, v2, s[44:47], 0 offen sc1
L_of_31:
  s_waitcnt vmcnt(0)
  v_cmp_ne_u32 vcc, s66, v3
  s_add_u32 s84, s84, 1
  s_nop 0
  s_and_b64 vcc, vcc, exec
  s_cbranch_scc0 L_of_ok_32
  s_cmp_gt_u32 s84, 400000
  s_cbranch_scc1 L_of_ok_32
  buffer_load_dword v3, v2, s[44:47], 0 offen sc1
  s_branch L_of_31
L_of_ok_32:
  s_branch L_e1
L_e1:
  s_barrier
  s_and_b32 s70, s61, 3
  s_lshl_b32 s70, s70, 1
  s_lshl_b32 s71, s60, 3
  s_add_u32 s70, s70, s71
  s_lshl_b32 s70, s70, 15
  s_lshl_b32 s72, s65, 12
  s_add_u32 s70, s70, s72
  s_add_u32 s70, s70, 14680064
  s_cmp_ge_u32 s65, 8
  s_cselect_b32 s73, 32768, 0
  s_add_u32 s72, s72, s73
  v_lshlrev_b32 v5, 4, v1
  s_add_u32 m0, s72, 32768
  s_add_u32 s71, s70, 0
  buffer_load_dwordx4 v5, s[44:47], s71 offen sc1 lds
  s_add_u32 m0, s72, 33792
  s_add_u32 s71, s70, 1024
  buffer_load_dwordx4 v5, s[44:47], s71 offen sc1 lds
  s_add_u32 m0, s72, 34816
  s_add_u32 s71, s70, 2048
  buffer_load_dwordx4 v5, s[44:47], s71 offen sc1 lds
  s_add_u32 m0, s72, 35840
  s_add_u32 s71, s70, 3072
  buffer_load_dwordx4 v5, s[44:47], s71 offen sc1 lds
  s_cmp_ge_u32 s65, 4
  s_cbranch_scc1 L_ys
  v_lshrrev_b32 v2, 5, v1
  v_bfe_u32 v3, v1, 2, 2
  v_lshl_add_u32 v2, v2, 2, v3
  v_lshlrev_b32 v2, 6, v2
  v_bfe_u32 v3, v1, 4, 1
  v_lshl_add_u32 v2, v3, 5, v2
  v_and_b32 v3, 3, v1
  v_lshl_add_u32 v2, v3, 3, v2
  s_lshr_b32 s70, s65, 1
  s_lshl_b32 s70, s70, 9
  v_add_u32 v6, s70, v2
  v_add_u32 v8, 65536, v6
  s_and_b32 s70, s65, 1
  s_lshl_b32 s70, s70, 16
  s_add_u32 s70, s70, 32768
  v_add_u32 v7, s70, v5
  s_waitcnt vmcnt(0)
  s_barrier
  ds_read_b64_tr_b16 v[32:33], v6 offset:0
  ds_read_b64_tr_b16 v[34:35], v6 offset:1024
  ds_read_b128 v[64:67], v7 offset:0
  ds_read_b64_tr_b16 v[36:37], v6 offset:2048
  ds_read_b64_tr_b16 v[38:39], v6 offset:3072
  ds_read_b128 v[68:71], v7 offset:1024
  ds_read_b64_tr_b16 v[40:41], v6 offset:4096
  ds_read_b64_tr_b16 v[42:43], v6 offset:5120
  ds_read_b128 v[72:75], v7 offset:2048
  ds_read_b64_tr_b16 v[44:45], v6 offset:6144
  ds_read_b64_tr_b16 v[46:47], v6 offset:7168
  ds_read_b128 v[76:79], v7 offset:3072
  ds_read_b64_tr_b16 v[48:49], v6 offset:8192
  ds_read_b64_tr_b16 v[50:51], v6 offset:9216
  ds_read_b128 v[80:83], v7 offset:4096
  s_waitcnt lgkmcnt(12)
  v_mfma_f32_32x32x16_bf16 v[16:31], v[32:35], v[64:67], 0
  ds_read_b64_tr_b16 v[32:33], v6 offset:10240
  ds_read_b64_tr_b16 v[34:35], v6 offset:11264
  ds_read_b128 v[64:67], v7 offset:5120
  s_waitcnt lgkmcnt(12)
  v_mfma_f32_32x32x16_bf16 v[16:31], v[36:39], v[68:71], v[16:31]
  ds_read_b64_tr_b16 v[36:37], v6 offset:12288
  ds_read_b64_tr_b16 v[38:39], v6 offset:13312
  ds_read_b128 v[68:71], v7 offset:6144
  s_waitcnt lgkmcnt(12)
  v_mfma_f32_32x32x16_bf16 v[16:31], v[40:43], v[72:75], v[16:31]
  ds_read_b64_tr_b16 v[40:41], v6 offset:14336
  ds_read_b64_tr_b16 v[42:43], v6 offset:15360
  ds_read_b128 v[72:75], v7 offset:7168
  s_waitcnt lgkmcnt(12)
  v_mfma_f32_32x32x16_bf16 v[16:31], v[44:47], v[76:79], v[16:31]
  ds_read_b64_tr_b16 v[44:45], v6 offset:16384
  ds_read_b64_tr_b16 v[46:47], v6 offset:17408
  ds_read_b128 v[76:79], v7 offset:8192
  s_waitcnt lgkmcnt(12)
  v_mfma_f32_32x32x16_bf16 v[16:31], v[48:51], v[80:83], v[16:31]
  ds_read_b64_tr_b16 v[48:49], v6 offset:18432
  ds_read_b64_tr_b16 v[50:51], v6 offset:19456
  ds_read_b128 v[80:83], v7 offset:9216
  s_waitcnt lgkmcnt(12)
  v_mfma_f32_32x32x16_bf16 v[16:31], v[32:35], v[64:67], v[16:31]
  ds_read_b64_tr_b16 v[32:33], v6 offset:20480
  ds_read_b64_tr_b16 v[34:35], v6 offset:21504
  ds_read_b128 v[64:67], v7 offset:10240
  s_waitcnt lgkmcnt(12)
  v_mfma_f32_32x32x16_bf16 v[16:31], v[36:39], v[68:71], v[16:31]
  ds_read_b64_tr_b16 v[36:37], v6 offset:22528
  ds_read_b64_tr_b16 v[38:39], v6 offset:23552
  ds_read_b128 v[68:71], v7 offset:11264
  s_waitcnt lgkmcnt(12)
  v_mfma_f32_32x32x16_bf16 v[16:31], v[40:43], v[72:75], v[16:31]
  ds_read_b64_tr_b16 v[40:41], v6 offset:24576
  ds_read_b64_tr_b16 v[42:43], v6 offset:25600
  ds_read_b128 v[72:75], v7 offset:12288
  s_waitcnt lgkmcnt(12)
  v_mfma_f32_32x32x16_bf16 v[16:31], v[44:47], v[76:79], v[16:31]
  ds_read_b64_tr_b16 v[44:45], v6 offset:26624
  ds_read_b64_tr_b16 v[46:47], v6 offset:27648
  ds_read_b128 v[76:79], v7 offset:13312
  s_waitcnt lgkmcnt(12)
  v_mfma_f32_32x32x16_bf16 v[16:31], v[48:51], v[80:83], v[16:31]
  ds_read_b64_tr_b16 v[48:49], v6 offset:28672
  ds_read_b64_tr_b16 v[50:51], v6 offset:29696
  ds_read_b128 v[80:83], v7 offset:14336
  s_waitcnt lgkmcnt(12)
  v_mfma_f32_32x32x16_bf16 v[16:31], v[32:35], v[64:67], v[16:31]
  ds_read_b64_tr_b16 v[32:33], v6 offset:30720
  ds_read_b64_tr_b16 v[34:35], v6 offset:31744
  ds_read_b128 v[64:67], v7 offset:15360
  s_waitcnt lgkmcnt(12)
  v_mfma_f32_32x32x16_bf16 v[16:31], v[36:39], v[68:71], v[16:31]
  ds_read_b64_tr_b16 v[36:37], v8 offset:0
  ds_read_b64_tr_b16 v[38:39], v8 offset:1024
  ds_read_b128 v[68:71], v7 offset:16384
  s_waitcnt lgkmcnt(12)
  v_mfma_f32_32x32x16_bf16 v[16:31], v[40:43], v[72:75], v[16:31]
  ds_read_b64_tr_b16 v[40:41], v8 offset:2048
  ds_read_b64_tr_b16 v[42:43], v8 offset:3072
  ds_read_b128 v[72:75], v7 offset:17408
  s_waitcnt lgkmcnt(12)
  v_mfma_f32_32x32x16_bf16 v[16:31], v[44:47], v[76:79], v[16:31]
  ds_read_b64_tr_b16 v[44:45], v8 offset:4096
  ds_read_b64_tr_b16 v[46:47], v8 offset:5120
  ds_read_b128 v[76:79], v7 offset:18432
  s_waitcnt lgkmcnt(12)
  v_mfma_f32_32x32x16_bf16 v[16:31], v[48:51], v[80:83], v[16:31]
  ds_read_b64_tr_b16 v[48:49], v8 offset:6144
  ds_read_b64_tr_b16 v[50:51], v8 offset:7168
  ds_read_b128 v[80:83], v7 offset:19456
  s_waitcnt lgkmcnt(12)
  v_mfma_f32_32x32x16_bf16 v[16:31], v[32:35], v[64:67], v[16:31]
  ds_read_b64_tr_b16 v[32:33], v8 offset:8192
  ds_read_b64_tr_b16 v[34:35], v8 offset:9216
  ds_read_b128 v[64:67], v7 offset:20480
  s_waitcnt lgkmcnt(12)
  v_mfma_f32_32x32x16_bf16 v[16:31], v[36:39], v[68:71], v[16:31]
  ds_read_b64_tr_b16 v[36:37], v8 offset:10240
  ds_read_b64_tr_b16 v[38:39], v8 offset:11264
  ds_read_b128 v[68:71], v7 offset:21504
  s_waitcnt lgkmcnt(12)
  v_mfma_f32_32x32x16_bf16 v[16:31], v[40:43], v[72:75], v[16:31]
  ds_read_b64_tr_b16 v[40:41], v8 offset:12288
  ds_read_b64_tr_b16 v[42:43], v8 offset:13312
  ds_read_b128 v[72:75], v7 offset:22528
  s_waitcnt lgkmcnt(12)
  v_mfma_f32_32x32x16_bf16 v[16:31], v[44:47], v[76:79], v[16:31]
  ds_read_b64_tr_b16 v[44:45], v8 offset:14336
  ds_read_b64_tr_b16 v[46:47], v8 offset:15360
  ds_read_b128 v[76:79], v7 offset:23552
  s_waitcnt lgkmcnt(12)
  v_mfma_f32_32x32x16_bf16 v[16:31], v[48:51], v[80:83], v[16:31]
  ds_read_b64_tr_b16 v[48:49], v8 offset:16384
  ds_read_b64_tr_b16 v[50:51], v8 offset:17408
  ds_read_b128 v[80:83], v7 offset:24576
  s_waitcnt lgkmcnt(12)
  v_mfma_f32_32x32x16_bf16 v[16:31], v[32:35], v[64:67], v[16:31]
  ds_read_b64_tr_b16 v[32:33], v8 offset:18432
  ds_read_b64_tr_b16 v[34:35], v8 offset:19456
  ds_read_b128 v[64:67], v7 offset:25600
  s_waitcnt lgkmcnt(12)
  v_mfma_f32_32x32x16_bf16 v[16:31], v[36:39], v[68:71], v[16:31]
  ds_read_b64_tr_b16 v[36:37], v8 offset:20480
  ds_read_b64_tr_b16 v[38:39], v8 offset:21504
  ds_read_b128 v[68:71], v7 offset:26624
  s_waitcnt lgkmcnt(12)
  v_mfma_f32_32x32x16_bf16 v[16:31], v[40:43], v[72:75], v[16:31]
  ds_read_b64_tr_b16 v[40:41], v8 offset:22528
  ds_read_b64_tr_b16 v[42:43], v8 offset:23552
  ds_read_b128 v[72:75], v7 offset:27648
  s_waitcnt lgkmcnt(12)
  v_mfma_f32_32x32x16_bf16 v[16:31], v[44:47], v[76:79], v[16:31]
  ds_read_b64_tr_b16 v[44:45], v8 offset:24576
  ds_read_b64_tr_b16 v[46:47], v8 offset:25600
  ds_read_b128 v[76:79], v7 offset:28672
  s_waitcnt lgkmcnt(12)
  v_mfma_f32_32x32x16_bf16 v[16:31], v[48:51], v[80:83], v[16:31]
  ds_read_b64_tr_b16 v[48:49], v8 offset:26624
  ds_read_b64_tr_b16 v[50:51], v8 offset:27648
  ds_read_b128 v[80:83], v7 offset:29696
  s_waitcnt lgkmcnt(12)
  v_mfma_f32_32x32x16_bf16 v[16:31], v[32:35], v[64:67], v[16:31]
  ds_read_b64_tr_b16 v[32:33], v8 offset:28672
  ds_read_b64_tr_b16 v[34:35], v8 offset:29696
  ds_read_b128 v[64:67], v7 offset:30720
  s_waitcnt lgkmcnt(12)
  v_mfma_f32_32x32x16_bf16 v[16:31], v[36:39], v[68:71], v[16:31]
  ds_read_b64_tr_b16 v[36:37], v8 offset:30720
  ds_read_b64_tr_b16 v[38:39], v8 offset:31744
  ds_read_b128 v[68:71], v7 offset:31744
  s_waitcnt lgkmcnt(12)
  v_mfma_f32_32x32x16_bf16 v[16:31], v[40:43], v[72:75], v[16:31]
  s_waitcnt lgkmcnt(9)
  v_mfma_f32_32x32x16_bf16 v[16:31], v[44:47], v[76:79], v[16:31]
  s_waitcnt lgkmcnt(6)
  v_mfma_f32_32x32x16_bf16 v[16:31], v[48:51], v[80:83], v[16:31]
  s_waitcnt lgkmcnt(3)
  v_mfma_f32_32x32x16_bf16 v[16:31], v[32:35], v[64:67], v[16:31]
  s_waitcnt lgkmcnt(0)
  v_mfma_f32_32x32x16_bf16 v[16:31], v[36:39], v[68:71], v[16:31]
  v_and_b32 v2, 31, v1
  s_and_b32 s70, s65, 1
  s_lshl_b32 s70, s70, 5
  v_add_u32 v2, s70, v2
  v_mul_u32_u24 v2, 144, v2
  v_lshrrev_b32 v3, 5, v1
  v_lshl_add_u32 v2, v3, 3, v2
  s_lshr_b32 s70, s65, 1
  s_lshl_b32 s70, s70, 6
  s_add_u32 s70, s70, 131072
  v_add_u32 v2, s70, v2
  s_nop 3
  v_cvt_pk_bf16_f32 v32, v16, v17
  v_cvt_pk_bf16_f32 v33, v18, v19
  ds_write_b64 v2, v[32:33] offset:0
  v_cvt_pk_bf16_f32 v34, v20, v21
  v_cvt_pk_bf16_f32 v35, v22, v23
  ds_write_b64 v2, v[34:35] offset:16
  v_cvt_pk_bf16_f32 v36, v24, v25
  v_cvt_pk_bf16_f32 v37, v26, v27
  ds_write_b64 v2, v[36:37] offset:32
  v_cvt_pk_bf16_f32 v38, v28, v29
  v_cvt_pk_bf16_f32 v39, v30, v31
  ds_write_b64 v2, v[38:39] offset:48
  s_waitcnt lgkmcnt(0)
  s_barrier
L_outstore:
  v_lshrrev_b32 v2, 3, v1
  s_lshl_b32 s70, s65, 3
  v_add_u32 v2, s70, v2
  v_mul_u32_u24 v3, 144, v2
  v_and_b32 v4, 7, v1
  v_lshl_add_u32 v3, v4, 4, v3
  v_add_u32 v3, 131072, v3
  ds_read_b128 v[8:11], v3
  v_lshlrev_b32 v2, 11, v2
  v_lshl_add_u32 v2, v4, 4, v2
  s_lshl_b32 s70, s60, 19
  s_and_b32 s72, s61, 3
  s_lshl_b32 s72, s72, 17
  s_add_u32 s70, s70, s72
  s_lshr_b32 s72, s61, 2
  s_lshl_b32 s72, s72, 7
  s_add_u32 s70, s70, s72
  s_waitcnt lgkmcnt(0)
  buffer_store_dwordx4 v[8:11], v2, s[56:59], s70 offen
  s_branch L_finish
L_ys:
  s_waitcnt vmcnt(0)
  s_barrier
  s_barrier
  s_cmp_lt_u32 s65, 8
  s_cbranch_scc1 L_outstore
  s_branch L_finish
L_conv:
  s_setprio 2
  s_lshl_b32 s70, s60, 6
  s_lshl_b32 s71, s61, 1
  s_add_u32 s70, s70, s71
  s_lshl_b32 s70, s70, 1
  s_load_dword s85, s[26:27], s70
  s_bfe_u32 s3, s65, 0x10002
  s_and_b32 s4, s65, 3
  s_mul_i32 s70, s3, 4608
  s_lshl_b32 s71, s4, 7
  s_sub_u32 s70, s70, s71
  s_add_u32 s70, s70, 148192
  v_and_b32 v5, 15, v1
  v_lshrrev_b32 v6, 4, v1
  v_lshlrev_b32 v7, 5, v5
  v_lshl_add_u32 v7, v6, 4, v7
  v_add_u32 v3, s70, v7
  s_mul_i32 s70, s3, 8320
  s_sub_u32 s70, s70, s71
  s_add_u32 s70, s70, 135132
  v_lshrrev_b32 v7, 1, v5
  v_lshlrev_b32 v7, 2, v7
  v_lshlrev_b32 v6, 4, v6
  v_sub_u32 v6, v6, v7
  v_and_b32 v5, 1, v5
  v_cmp_eq_u32 vcc, 0, v5
  v_mov_b32 v7, 4160
  s_nop 0
  v_cndmask_b32 v5, 0, v7, vcc
  v_add_u32 v6, v6, v5
  v_add_u32 v2, s70, v6
  v_subrev_u32 v4, 512, v2
  ds_read2_b32 v[40:41], v4 offset0:128 offset1:129
  ds_read2_b32 v[42:43], v4 offset0:130 offset1:131
  ds_read_b128 v[72:75], v3 offset:0
  ds_read_b128 v[76:79], v3 offset:512
  ds_read_b128 v[80:83], v3 offset:1024
  ds_read_b128 v[84:87], v3 offset:1536
  ds_read_b128 v[88:91], v3 offset:2048
  ds_read_b128 v[92:95], v3 offset:2560
  ds_read_b128 v[96:99], v3 offset:3072
  ds_read_b128 v[100:103], v3 offset:3584
  ds_read2_b32 v[44:45], v4 offset0:0 offset1:1
  ds_read2_b32 v[46:47], v4 offset0:2 offset1:3
  s_waitcnt lgkmcnt(9)
  v_mfma_f32_16x16x32_bf16 v[8:11], v[40:43], v[72:75], 0
  s_waitcnt lgkmcnt(8)
  v_mfma_f32_16x16x32_bf16 v[12:15], v[40:43], v[76:79], 0
  v_subrev_u32 v5, 1536, v2
  ds_read2_b32 v[48:49], v5 offset0:128 offset1:129
  ds_read2_b32 v[50:51], v5 offset0:130 offset1:131
  s_waitcnt lgkmcnt(9)
  v_mfma_f32_16x16x32_bf16 v[16:19], v[40:43], v[80:83], 0
  s_waitcnt lgkmcnt(8)
  v_mfma_f32_16x16x32_bf16 v[20:23], v[40:43], v[84:87], 0
  ds_read2_b32 v[52:53], v5 offset0:0 offset1:1
  ds_read2_b32 v[54:55], v5 offset0:2 offset1:3
  s_waitcnt lgkmcnt(9)
  v_mfma_f32_16x16x32_bf16 v[24:27], v[40:43], v[88:91], 0
  s_waitcnt lgkmcnt(8)
  v_mfma_f32_16x16x32_bf16 v[28:31], v[40:43], v[92:95], 0
  v_subrev_u32 v4, 2560, v2
  ds_read2_b32 v[56:57], v4 offset0:128 offset1:129
  ds_read2_b32 v[58:59], v4 offset0:130 offset1:131
  s_waitcnt lgkmcnt(9)
  v_mfma_f32_16x16x32_bf16 v[32:35], v[40:43], v[96:99], 0
  s_waitcnt lgkmcnt(8)
  v_mfma_f32_16x16x32_bf16 v[36:39], v[40:43], v[100:103], 0
  s_waitcnt lgkmcnt(6)
  v_mfma_f32_16x16x32_bf16 v[12:15], v[44:47], v[72:75], v[12:15]
  ds_read2_b32 v[60:61], v4 offset0:0 offset1:1
  ds_read2_b32 v[62:63], v4 offset0:2 offset1:3
  v_mfma_f32_16x16x32_bf16 v[16:19], v[44:47], v[76:79], v[16:19]
  v_mfma_f32_16x16x32_bf16 v[20:23], v[44:47], v[80:83], v[20:23]
  v_subrev_u32 v5, 3584, v2
  ds_read2_b32 v[64:65], v5 offset0:128 offset1:129
  ds_read2_b32 v[66:67], v5 offset0:130 offset1:131
  v_mfma_f32_16x16x32_bf16 v[24:27], v[44:47], v[84:87], v[24:27]
  v_mfma_f32_16x16x32_bf16 v[28:31], v[44:47], v[88:91], v[28:31]
  ds_read2_b32 v[68:69], v5 offset0:0 offset1:1
  ds_read2_b32 v[70:71], v5 offset0:2 offset1:3
  v_mfma_f32_16x16x32_bf16 v[32:35], v[44:47], v[92:95], v[32:35]
  v_mfma_f32_16x16x32_bf16 v[36:39], v[44:47], v[96:99], v[36:39]
  s_waitcnt lgkmcnt(10)
  v_mfma_f32_16x16x32_bf16 v[16:19], v[48:51], v[72:75], v[16:19]
  v_mfma_f32_16x16x32_bf16 v[20:23], v[48:51], v[76:79], v[20:23]
  v_mfma_f32_16x16x32_bf16 v[24:27], v[48:51], v[80:83], v[24:27]
  v_mfma_f32_16x16x32_bf16 v[28:31], v[48:51], v[84:87], v[28:31]
  v_mfma_f32_16x16x32_bf16 v[32:35], v[48:51], v[88:91], v[32:35]
  v_mfma_f32_16x16x32_bf16 v[36:39], v[48:51], v[92:95], v[36:39]
  s_waitcnt lgkmcnt(8)
  v_mfma_f32_16x16x32_bf16 v[20:23], v[52:55], v[72:75], v[20:23]
  v_mfma_f32_16x16x32_bf16 v[24:27], v[52:55], v[76:79], v[24:27]
  v_mfma_f32_16x16x32_bf16 v[28:31], v[52:55], v[80:83], v[28:31]
  v_mfma_f32_16x16x32_bf16 v[32:35], v[52:55], v[84:87], v[32:35]
  v_mfma_f32_16x16x32_bf16 v[36:39], v[52:55], v[88:91], v[36:39]
  s_waitcnt lgkmcnt(6)
  v_mfma_f32_16x16x32_bf16 v[24:27], v[56:59], v[72:75], v[24:27]
  v_mfma_f32_16x16x32_bf16 v[28:31], v[56:59], v[76:79], v[28:31]
  v_mfma_f32_16x16x32_bf16 v[32:35], v[56:59], v[80:83], v[32:35]
  v_mfma_f32_16x16x32_bf16 v[36:39], v[56:59], v[84:87], v[36:39]
  s_waitcnt lgkmcnt(4)
  v_mfma_f32_16x16x32_bf16 v[28:31], v[60:63], v[72:75], v[28:31]
  v_mfma_f32_16x16x32_bf16 v[32:35], v[60:63], v[76:79], v[32:35]
  v_mfma_f32_16x16x32_bf16 v[36:39], v[60:63], v[80:83], v[36:39]
  s_waitcnt lgkmcnt(2)
  v_mfma_f32_16x16x32_bf16 v[32:35], v[64:67], v[72:75], v[32:35]
  v_mfma_f32_16x16x32_bf16 v[36:39], v[64:67], v[76:79], v[36:39]
  s_waitcnt lgkmcnt(0)
  v_mfma_f32_16x16x32_bf16 v[36:39], v[68:71], v[72:75], v[36:39]
  v_subrev_u32 v2, 64, v2
  v_subrev_u32 v3, 64, v3
  v_subrev_u32 v4, 512, v2
  ds_read2_b32 v[40:41], v4 offset0:128 offset1:129
  ds_read2_b32 v[42:43], v4 offset0:130 offset1:131
  ds_read_b128 v[72:75], v3 offset:0
  ds_read_b128 v[76:79], v3 offset:512
  ds_read_b128 v[80:83], v3 offset:1024
  ds_read_b128 v[84:87], v3 offset:1536
  ds_read_b128 v[88:91], v3 offset:2048
  ds_read_b128 v[92:95], v3 offset:2560
  ds_read_b128 v[96:99], v3 offset:3072
  ds_read_b128 v[100:103], v3 offset:3584
  ds_read2_b32 v[44:45], v4 offset0:0 offset1:1
  ds_read2_b32 v[46:47], v4 offset0:2 offset1:3
  s_waitcnt lgkmcnt(9)
  v_mfma_f32_16x16x32_bf16 v[8:11], v[40:43], v[72:75], v[8:11]
  s_waitcnt lgkmcnt(8)
  v_mfma_f32_16x16x32_bf16 v[12:15], v[40:43], v[76:79], v[12:15]
  v_subrev_u32 v5, 1536, v2
  ds_read2_b32 v[48:49], v5 offset0:128 offset1:129
  ds_read2_b32 v[50:51], v5 offset0:130 offset1:131
  s_waitcnt lgkmcnt(9)
  v_mfma_f32_16x16x32_bf16 v[16:19], v[40:43], v[80:83], v[16:19]
  s_waitcnt lgkmcnt(8)
  v_mfma_f32_16x16x32_bf16 v[20:23], v[40:43], v[84:87], v[20:23]
  ds_read2_b32 v[52:53], v5 offset0:0 offset1:1
  ds_read2_b32 v[54:55], v5 offset0:2 offset1:3
  s_waitcnt lgkmcnt(9)
  v_mfma_f32_16x16x32_bf16 v[24:27], v[40:43], v[88:91], v[24:27]
  s_waitcnt lgkmcnt(8)
  v_mfma_f32_16x16x32_bf16 v[28:31], v[40:43], v[92:95], v[28:31]
  v_subrev_u32 v4, 2560, v2
  ds_read2_b32 v[56:57], v4 offset0:128 offset1:129
  ds_read2_b32 v[58:59], v4 offset0:130 offset1:131
  s_waitcnt lgkmcnt(9)
  v_mfma_f32_16x16x32_bf16 v[32:35], v[40:43], v[96:99], v[32:35]
  s_waitcnt lgkmcnt(8)
  v_mfma_f32_16x16x32_bf16 v[36:39], v[40:43], v[100:103], v[36:39]
  s_waitcnt lgkmcnt(6)
  v_mfma_f32_16x16x32_bf16 v[12:15], v[44:47], v[72:75], v[12:15]
  ds_read2_b32 v[60:61], v4 offset0:0 offset1:1
  ds_read2_b32 v[62:63], v4 offset0:2 offset1:3
  v_mfma_f32_16x16x32_bf16 v[16:19], v[44:47], v[76:79], v[16:19]
  v_mfma_f32_16x16x32_bf16 v[20:23], v[44:47], v[80:83], v[20:23]
  v_subrev_u32 v5, 3584, v2
  ds_read2_b32 v[64:65], v5 offset0:128 offset1:129
  ds_read2_b32 v[66:67], v5 offset0:130 offset1:131
  v_mfma_f32_16x16x32_bf16 v[24:27], v[44:47], v[84:87], v[24:27]
  v_mfma_f32_16x16x32_bf16 v[28:31], v[44:47], v[88:91], v[28:31]
  ds_read2_b32 v[68:69], v5 offset0:0 offset1:1
  ds_read2_b32 v[70:71], v5 offset0:2 offset1:3
  v_mfma_f32_16x16x32_bf16 v[32:35], v[44:47], v[92:95], v[32:35]
  v_mfma_f32_16x16x32_bf16 v[36:39], v[44:47], v[96:99], v[36:39]
  s_waitcnt lgkmcnt(10)
  v_mfma_f32_16x16x32_bf16 v[16:19], v[48:51], v[72:75], v[16:19]
  v_mfma_f32_16x16x32_bf16 v[20:23], v[48:51], v[76:79], v[20:23]
  v_mfma_f32_16x16x32_bf16 v[24:27], v[48:51], v[80:83], v[24:27]
  v_mfma_f32_16x16x32_bf16 v[28:31], v[48:51], v[84:87], v[28:31]
  v_mfma_f32_16x16x32_bf16 v[32:35], v[48:51], v[88:91], v[32:35]
  v_mfma_f32_16x16x32_bf16 v[36:39], v[48:51], v[92:95], v[36:39]
  s_waitcnt lgkmcnt(8)
  v_mfma_f32_16x16x32_bf16 v[20:23], v[52:55], v[72:75], v[20:23]
  v_mfma_f32_16x16x32_bf16 v[24:27], v[52:55], v[76:79], v[24:27]
  v_mfma_f32_16x16x32_bf16 v[28:31], v[52:55], v[80:83], v[28:31]
  v_mfma_f32_16x16x32_bf16 v[32:35], v[52:55], v[84:87], v[32:35]
  v_mfma_f32_16x16x32_bf16 v[36:39], v[52:55], v[88:91], v[36:39]
  s_waitcnt lgkmcnt(6)
  v_mfma_f32_16x16x32_bf16 v[24:27], v[56:59], v[72:75], v[24:27]
  v_mfma_f32_16x16x32_bf16 v[28:31], v[56:59], v[76:79], v[28:31]
  v_mfma_f32_16x16x32_bf16 v[32:35], v[56:59], v[80:83], v[32:35]
  v_mfma_f32_16x16x32_bf16 v[36:39], v[56:59], v[84:87], v[36:39]
  s_waitcnt lgkmcnt(4)
  v_mfma_f32_16x16x32_bf16 v[28:31], v[60:63], v[72:75], v[28:31]
  v_mfma_f32_16x16x32_bf16 v[32:35], v[60:63], v[76:79], v[32:35]
  v_mfma_f32_16x16x32_bf16 v[36:39], v[60:63], v[80:83], v[36:39]
  s_waitcnt lgkmcnt(2)
  v_mfma_f32_16x16x32_bf16 v[32:35], v[64:67], v[72:75], v[32:35]
  v_mfma_f32_16x16x32_bf16 v[36:39], v[64:67], v[76:79], v[36:39]
  s_waitcnt lgkmcnt(0)
  v_mfma_f32_16x16x32_bf16 v[36:39], v[68:71], v[72:75], v[36:39]
  v_lshlrev_b32 v5, 4, v1
  s_lshl_b32 s72, s3, 16
  s_add_u32 s72, s72, 32768
  s_lshl_b32 s70, s4, 13
  s_add_u32 s70, s70, s72
  v_add_u32 v6, s70, v5
  s_waitcnt lgkmcnt(0)
  ds_write_b128 v6, v[8:11] offset:0
  ds_write_b128 v6, v[12:15] offset:1024
  ds_write_b128 v6, v[16:19] offset:2048
  ds_write_b128 v6, v[20:23] offset:3072
  ds_write_b128 v6, v[24:27] offset:4096
  ds_write_b128 v6, v[28:31] offset:5120
  ds_write_b128 v6, v[32:35] offset:6144
  ds_write_b128 v6, v[36:39] offset:7168
  s_and_b32 s70, s65, 7
  s_lshl_b32 s70, s70, 2
  s_add_u32 s70, s70, 163440
  v_mov_b32 v6, s70
  v_mov_b32 v7, s66
  s_waitcnt lgkmcnt(0)
  ds_write_b32 v6, v7
  s_lshl_b32 s70, s3, 4
  s_add_u32 s70, s70, 163440
  v_mov_b32 v6, s70
  s_mov_b32 s84, 0
L_lspin_33:
  ds_read_b128 v[8:11], v6 offset:0
  s_add_u32 s84, s84, 1
  s_waitcnt lgkmcnt(0)
  v_cmp_ne_u32 vcc, s66, v8
  v_cmp_ne_u32 s[6:7], s66, v9
  s_nop 0
  s_or_b64 vcc, vcc, s[6:7]
  v_cmp_ne_u32 s[6:7], s66, v10
  s_nop 0
  s_or_b64 vcc, vcc, s[6:7]
  v_cmp_ne_u32 s[6:7], s66, v11
  s_nop 0
  s_or_b64 vcc, vcc, s[6:7]
  s_cbranch_vccz L_lspin_33_x
  s_cmp_gt_u32 s84, 400000
  s_cbranch_scc0 L_lspin_33
L_lspin_33_x:
  s_lshl_b32 s71, s4, 11
  s_add_u32 s70, s72, s71
  v_add_u32 v6, s70, v5
  ds_read_b128 v[40:43], v6 offset:0
  ds_read_b128 v[56:59], v6 offset:1024
  ds_read_b128 v[44:47], v6 offset:8192
  ds_read_b128 v[60:63], v6 offset:9216
  ds_read_b128 v[48:51], v6 offset:16384
  ds_read_b128 v[64:67], v6 offset:17408
  ds_read_b128 v[52:55], v6 offset:24576
  ds_read_b128 v[68:71], v6 offset:25600
  s_mul_i32 s70, s3, 4608
  s_lshl_b32 s71, s4, 10
  s_add_u32 s70, s70, s71
  s_add_u32 s70, s70, 148224
  v_and_b32 v7, 15, v1
  v_lshlrev_b32 v7, 5, v7
  v_lshrrev_b32 v8, 4, v1
  v_lshl_add_u32 v7, v8, 3, v7
  v_add_u32 v7, s70, v7
  ds_read_b64 v[72:73], v7
  ds_read_b64 v[74:75], v7 offset:512
  s_waitcnt lgkmcnt(0)
  s_lshl_b32 s71, s3, 4
  s_lshr_b32 s85, s85, s71
  s_lshl_b32 s85, s85, 16
  v_add_f32 v40, v40, v44
  v_add_f32 v48, v48, v52
  v_add_f32 v41, v41, v45
  v_add_f32 v49, v49, v53
  v_add_f32 v42, v42, v46
  v_add_f32 v50, v50, v54
  v_add_f32 v43, v43, v47
  v_add_f32 v51, v51, v55
  v_add_f32 v40, v40, v48
  v_add_f32 v41, v41, v49
  v_add_f32 v42, v42, v50
  v_add_f32 v43, v43, v51
  v_cvt_pk_bf16_f32 v44, v40, v41
  v_cvt_pk_bf16_f32 v45, v42, v43
  v_lshlrev_b32 v48, 16, v72
  v_and_b32 v49, 0xffff0000, v72
  v_lshlrev_b32 v50, 16, v73
  v_and_b32 v51, 0xffff0000, v73
  v_mul_f32 v48, s85, v48
  v_mul_f32 v49, s85, v49
  v_mul_f32 v50, s85, v50
  v_mul_f32 v51, s85, v51
  v_cvt_pk_bf16_f32 v46, v48, v49
  v_cvt_pk_bf16_f32 v47, v50, v51
  v_lshlrev_b32 v48, 16, v44
  v_and_b32 v49, 0xffff0000, v44
  v_lshlrev_b32 v50, 16, v46
  v_and_b32 v51, 0xffff0000, v46
  v_add_f32 v48, v48, v50
  v_add_f32 v49, v49, v51
  v_cvt_pk_bf16_f32 v76, v48, v49
  v_lshlrev_b32 v48, 16, v45
  v_and_b32 v49, 0xffff0000, v45
  v_lshlrev_b32 v50, 16, v47
  v_and_b32 v51, 0xffff0000, v47
  v_add_f32 v48, v48, v50
  v_add_f32 v49, v49, v51
  v_cvt_pk_bf16_f32 v77, v48, v49
  v_add_f32 v56, v56, v60
  v_add_f32 v64, v64, v68
  v_add_f32 v57, v57, v61
  v_add_f32 v65, v65, v69
  v_add_f32 v58, v58, v62
  v_add_f32 v66, v66, v70
  v_add_f32 v59, v59, v63
  v_add_f32 v67, v67, v71
  v_add_f32 v56, v56, v64
  v_add_f32 v57, v57, v65
  v_add_f32 v58, v58, v66
  v_add_f32 v59, v59, v67
  v_cvt_pk_bf16_f32 v60, v56, v57
  v_cvt_pk_bf16_f32 v61, v58, v59
  v_lshlrev_b32 v64, 16, v74
  v_and_b32 v65, 0xffff0000, v74
  v_lshlrev_b32 v66, 16, v75
  v_and_b32 v67, 0xffff0000, v75
  v_mul_f32 v64, s85, v64
  v_mul_f32 v65, s85, v65
  v_mul_f32 v66, s85, v66
  v_mul_f32 v67, s85, v67
  v_cvt_pk_bf16_f32 v62, v64, v65
  v_cvt_pk_bf16_f32 v63, v66, v67
  v_lshlrev_b32 v64, 16, v60
  v_and_b32 v65, 0xffff0000, v60
  v_lshlrev_b32 v66, 16, v62
  v_and_b32 v67, 0xffff0000, v62
  v_add_f32 v64, v64, v66
  v_add_f32 v65, v65, v67
  v_cvt_pk_bf16_f32 v78, v64, v65
  v_lshlrev_b32 v64, 16, v61
  v_and_b32 v65, 0xffff0000, v61
  v_lshlrev_b32 v66, 16, v63
  v_and_b32 v67, 0xffff0000, v63
  v_add_f32 v64, v64, v66
  v_add_f32 v65, v65, v67
  v_cvt_pk_bf16_f32 v79, v64, v65
  s_lshl_b32 s70, s60, 6
  s_lshl_b32 s71, s61, 1
  s_add_u32 s70, s70, s71
  s_add_u32 s70, s70, s3
  s_lshl_b32 s70, s70, 2
  s_add_u32 s70, s70, s4
  s_lshl_b32 s70, s70, 10
  s_add_u32 s70, s70, 16777216
  s_cmp_eq_u32 s67, 0
  s_cbranch_scc1 L_wt_34
  buffer_store_dwordx4 v[76:79], v5, s[44:47], s70 offen
  s_branch L_std_35
L_wt_34:
  buffer_store_dwordx4 v[76:79], v5, s[44:47], s70 offen sc1
L_std_35:
  s_lshl_b32 s70, s4, 17
  s_lshl_b32 s71, s60, 11
  s_add_u32 s70, s70, s71
  s_lshl_b32 s71, s61, 3
  s_add_u32 s70, s70, s71
  s_lshl_b32 s71, s3, 2
  s_add_u32 s70, s70, s71
  s_add_u32 s3, s70, 1049856
  s_setprio 0
  s_barrier
  v_lshlrev_b32 v4, 4, v1
  v_lshlrev_b32 v5, 2, v1
  s_add_u32 s70, s86, 0
  v_add_u32 v5, s70, v5
  v_add_u32 v8, 10240, v4
  ds_read_b128 v[72:75], v8
  s_lshl_b32 s70, s60, 3
  s_lshl_b64 s[6:7], 0xff, s70
  v_lshrrev_b32 v2, 5, v1
  v_lshlrev_b32 v2, 8, v2
  v_and_b32 v3, 15, v1
  v_lshl_add_u32 v2, v3, 4, v2
  v_add_u32 v9, 75776, v2
  v_and_b32 v2, 27, v1
  v_cmp_eq_u32 vcc, 16, v2
  v_mov_b32 v3, 0x3f803f80
  s_nop 0
  v_cndmask_b32 v2, 0, v3, vcc
  v_mov_b32 v80, v2
  v_mov_b32 v81, v2
  v_mov_b32 v82, v2
  v_mov_b32 v83, v2
  v_mov_b32 v84, v2
  v_mov_b32 v85, v2
  v_mov_b32 v86, v2
  v_mov_b32 v87, v2
  v_mov_b32 v88, v2
  v_mov_b32 v89, v2
  v_mov_b32 v90, v2
  v_mov_b32 v91, v2
  v_mov_b32 v92, v2
  v_mov_b32 v93, v2
  v_mov_b32 v94, v2
  v_mov_b32 v95, v2
  s_mov_b64 exec, s[78:79]
  ds_read_b128 v[80:83], v9
  ds_read_b128 v[84:87], v9 offset:512
  s_mov_b64 exec, -1
  v_mov_b32 v16, 0
  v_mov_b32 v17, 0
  v_mov_b32 v18, 0
  v_mov_b32 v19, 0
  v_mov_b32 v20, 0
  v_mov_b32 v21, 0
  v_mov_b32 v22, 0
  v_mov_b32 v23, 0
  v_mov_b32 v24, 0
  v_mov_b32 v25, 0
  v_mov_b32 v26, 0
  v_mov_b32 v27, 0
  v_mov_b32 v28, 0
  v_mov_b32 v29, 0
  v_mov_b32 v30, 0
  v_mov_b32 v31, 0
  v_mov_b32 v64, 0
  v_mov_b32 v65, 0
  v_mov_b32 v66, 0
  v_mov_b32 v67, 0
  v_mov_b32 v68, 0
  v_mov_b32 v69, 0
  v_mov_b32 v70, 0
  v_mov_b32 v71, 0
  s_waitcnt lgkmcnt(2)
  v_mfma_f32_32x32x16_bf16 v[32:47], v[72:75], v[108:111], 0
  s_nop 7
  s_nop 3
  s_branch L_at_shared
L_at_r2:
  s_waitcnt vmcnt(0)
  s_barrier
  s_branch L_at_r2back
L_at_hook:
  s_cmp_eq_u32 s34, 2
  s_cbranch_scc0 L_at_hook3
  s_cmp_eq_u32 s65, 0
  s_cbranch_scc0 L_at_noot
  s_cmp_eq_u32 s67, 1
  s_cbranch_scc0 L_at_back
  v_lshrrev_b32 v2, 3, v1
  v_lshlrev_b32 v2, 15, v2
  v_and_b32 v3, 7, v1
  v_lshl_add_u32 v2, v3, 7, v2
  s_lshl_b32 s70, s60, 18
  s_lshl_b32 s71, s68, 10
  s_add_u32 s70, s70, s71
  s_add_u32 s70, s70, 14680064
  buffer_load_dword v10, v2, s[44:47], s70 offen
  s_branch L_at_back
L_at_noot:
  s_cmp_lt_u32 s65, 8
  s_cbranch_scc1 L_at_back
  v_lshlrev_b32 v2, 2, v1
  s_add_u32 s70, s86, 1280
  v_add_u32 v2, s70, v2
  s_mov_b32 s84, 0
  buffer_load_dword v3, v2, s[44:47], 0 offen sc1
L_yf_36:
  s_waitcnt vmcnt(0)
  v_cmp_ne_u32 vcc, s66, v3
  s_add_u32 s84, s84, 1
  s_nop 0
  s_and_b64 vcc, vcc, exec
  s_cbranch_scc0 L_yf_ok_37
  s_cmp_gt_u32 s84, 400000
  s_cbranch_scc1 L_yf_ok_37
  buffer_load_dword v3, v2, s[44:47], 0 offen sc1
  s_branch L_yf_36
L_yf_ok_37:
  v_lshrrev_b32 v2, 4, v1
  v_lshlrev_b32 v2, 12, v2
  v_bfe_u32 v3, v1, 2, 2
  v_lshl_add_u32 v2, v3, 8, v2
  v_and_b32 v3, 3, v1
  v_lshl_add_u32 v2, v3, 4, v2
  s_lshl_b32 s70, s60, 18
  s_lshr_b32 s71, s61, 3
  s_lshl_b32 s71, s71, 10
  s_add_u32 s70, s70, s71
  s_and_b32 s71, s61, 3
  s_lshl_b32 s71, s71, 6
  s_add_u32 s70, s70, s71
  s_and_b32 s72, s65, 7
  s_lshl_b32 s71, s72, 15
  s_add_u32 s70, s70, s71
  s_add_u32 s70, s70, 16777216
  s_mul_i32 s73, s72, 2080
  s_add_u32 m0, s73, 140288
  s_add_u32 s71, s70, 0
  buffer_load_dwordx4 v2, s[44:47], s71 offen sc1 lds
  s_add_u32 m0, s73, 141328
  s_add_u32 s71, s70, 16384
  buffer_load_dwordx4 v2, s[44:47], s71 offen sc1 lds
  s_branch L_at_back
L_at_hook3:
  s_waitcnt vmcnt(0)
  s_barrier
  v_lshrrev_b32 v2, 2, v1
  v_and_b32 v2, 7, v2
  v_lshlrev_b32 v2, 10, v2
  v_lshrrev_b32 v3, 5, v1
  v_lshl_add_u32 v2, v3, 6, v2
  v_and_b32 v3, 3, v1
  v_lshl_add_u32 v2, v3, 4, v2
  s_lshl_b32 s70, s65, 15
  s_lshr_b32 s71, s61, 2
  s_lshl_b32 s71, s71, 7
  s_add_u32 s70, s70, s71
  s_lshl_b32 s72, s65, 12
  s_cmp_ge_u32 s65, 8
  s_cselect_b32 s73, 32768, 0
  s_add_u32 s72, s72, s73
  s_add_u32 m0, s72, 0
  s_add_u32 s71, s70, 0
  buffer_load_dwordx4 v2, s[52:55], s71 offen lds
  s_add_u32 m0, s72, 1024
  s_add_u32 s71, s70, 8192
  buffer_load_dwordx4 v2, s[52:55], s71 offen lds
  s_add_u32 m0, s72, 2048
  s_add_u32 s71, s70, 16384
  buffer_load_dwordx4 v2, s[52:55], s71 offen lds
  s_add_u32 m0, s72, 3072
  s_add_u32 s71, s70, 24576
  buffer_load_dwordx4 v2, s[52:55], s71 offen lds
  s_cmp_lt_u32 s65, 8
  s_cbranch_scc1 L_at_back
  s_and_b32 s72, s65, 7
  v_and_b32 v3, 7, v1
  v_mul_u32_u24 v10, 2080, v3
  v_bfe_u32 v11, v1, 5, 1
  v_lshl_add_u32 v10, v11, 6, v10
  v_bfe_u32 v11, v1, 3, 2
  v_lshl_add_u32 v10, v11, 1, v10
  s_bfe_u32 s70, s61, 0x10002
  s_lshl_b32 s70, s70, 3
  s_lshr_b32 s71, s72, 1
  s_lshl_b32 s71, s71, 4
  s_add_u32 s70, s70, s71
  s_and_b32 s71, s72, 1
  s_lshl_b32 s71, s71, 7
  s_add_u32 s70, s70, s71
  s_add_u32 s70, s70, 140288
  v_add_u32 v10, s70, v10
  ds_read_u16 v100, v10 offset:0
  ds_read_u16_d16_hi v101, v10 offset:256
  ds_read_u16 v102, v10 offset:512
  ds_read_u16_d16_hi v103, v10 offset:768
  ds_read_u16 v104, v10 offset:1040
  ds_read_u16_d16_hi v105, v10 offset:1296
  ds_read_u16 v106, v10 offset:1552
  ds_read_u16_d16_hi v107, v10 offset:1808
  v_lshrrev_b32 v2, 3, v1
  s_lshl_b32 s71, s72, 3
  v_add_u32 v2, s71, v2
  v_lshlrev_b32 v2, 11, v2
  v_lshl_add_u32 v2, v3, 4, v2
  s_lshl_b32 s70, s61, 17
  s_lshl_b32 s71, s60, 7
  s_add_u32 s70, s70, s71
  s_add_u32 s70, s70, 1024
  s_waitcnt lgkmcnt(0)
  v_or_b32 v96, v100, v101
  v_or_b32 v97, v102, v103
  v_or_b32 v98, v104, v105
  v_or_b32 v99, v106, v107
  buffer_store_dwordx4 v[96:99], v2, s[56:59], s70 offen
  s_branch L_at_back
L_at_fallback:
  v_mov_b32 v2, 0xff61b1e6
  s_mov_b32 s82, 0
L_fb_max:
  s_lshr_b32 s70, s82, 2
  s_lshl_b32 s71, s60, 1
  s_add_u32 s71, s71, s70
  s_and_b32 s71, s71, 15
  s_lshl_b32 s71, s71, 12
  s_and_b32 s72, s82, 3
  s_lshl_b32 s72, s72, 10
  s_add_u32 s71, s71, s72
  s_lshl_b32 s72, s68, 16
  s_add_u32 s71, s71, s72
  s_cmp_lt_u32 s70, 2
  s_cselect_b32 s72, 6291456, 0
  s_add_u32 s71, s71, s72
  s_add_u32 s73, s71, 6291456
  s_add_u32 s71, s71, 4194304
  buffer_load_dwordx4 v[72:75], v4, s[44:47], s71 offen sc1
  s_waitcnt vmcnt(0)
  v_mfma_f32_32x32x16_bf16 v[32:47], v[72:75], v[108:111], 0
  s_nop 7
  s_nop 3
  v_max3_f32 v2, v2, v32, v33
  v_max3_f32 v2, v2, v34, v35
  v_max3_f32 v2, v2, v36, v37
  v_max3_f32 v2, v2, v38, v39
  v_max3_f32 v2, v2, v40, v41
  v_max3_f32 v2, v2, v42, v43
  v_max3_f32 v2, v2, v44, v45
  v_max3_f32 v2, v2, v46, v47
  s_add_u32 s82, s82, 1
  s_cmp_lt_u32 s82, 64
  s_cbranch_scc1 L_fb_max
  v_mov_b32 v3, v2
  s_nop 1
  v_permlane32_swap_b32 v2, v3
  s_nop 1
  v_max_f32 v2, v2, v3
  v_sub_f32 v48, 0, v2
  v_sub_f32 v49, 0, v2
  v_sub_f32 v50, 0, v2
  v_sub_f32 v51, 0, v2
  v_sub_f32 v52, 0, v2
  v_sub_f32 v53, 0, v2
  v_sub_f32 v54, 0, v2
  v_sub_f32 v55, 0, v2
  v_sub_f32 v56, 0, v2
  v_sub_f32 v57, 0, v2
  v_sub_f32 v58, 0, v2
  v_sub_f32 v59, 0, v2
  v_sub_f32 v60, 0, v2
  v_sub_f32 v61, 0, v2
  v_sub_f32 v62, 0, v2
  v_sub_f32 v63, 0, v2
  v_mov_b32 v16, 0
  v_mov_b32 v17, 0
  v_mov_b32 v18, 0
  v_mov_b32 v19, 0
  v_mov_b32 v20, 0
  v_mov_b32 v21, 0
  v_mov_b32 v22, 0
  v_mov_b32 v23, 0
  v_mov_b32 v24, 0
  v_mov_b32 v25, 0
  v_mov_b32 v26, 0
  v_mov_b32 v27, 0
  v_mov_b32 v28, 0
  v_mov_b32 v29, 0
  v_mov_b32 v30, 0
  v_mov_b32 v31, 0
  v_lshrrev_b32 v2, 5, v1
  v_lshlrev_b32 v2, 8, v2
  v_and_b32 v3, 15, v1
  v_lshl_add_u32 v9, v3, 4, v2
  s_mov_b32 s82, 0
L_fb_sum:
  s_lshr_b32 s70, s82, 2
  s_lshl_b32 s71, s60, 1
  s_add_u32 s71, s71, s70
  s_and_b32 s71, s71, 15
  s_lshl_b32 s71, s71, 12
  s_and_b32 s72, s82, 3
  s_lshl_b32 s72, s72, 10
  s_add_u32 s71, s71, s72
  s_lshl_b32 s72, s68, 16
  s_add_u32 s71, s71, s72
  s_cmp_lt_u32 s70, 2
  s_cselect_b32 s72, 6291456, 0
  s_add_u32 s71, s71, s72
  s_add_u32 s73, s71, 6291456
  s_add_u32 s71, s71, 4194304
  buffer_load_dwordx4 v[72:75], v4, s[44:47], s71 offen sc1
  s_mov_b64 exec, s[78:79]
  buffer_load_dwordx4 v[80:83], v9, s[44:47], s73 offen sc1
  buffer_load_dwordx4 v[84:87], v9, s[44:47], s73 offen offset:512 sc1
  s_mov_b64 exec, -1
  s_waitcnt vmcnt(0)
  v_mfma_f32_32x32x16_bf16 v[32:47], v[72:75], v[108:111], v[48:63]
  s_nop 7
  s_nop 3
  v_exp_f32 v32, v32
  v_exp_f32 v33, v33
  v_exp_f32 v34, v34
  v_exp_f32 v35, v35
  v_exp_f32 v36, v36
  v_exp_f32 v37, v37
  v_exp_f32 v38, v38
  v_exp_f32 v39, v39
  v_exp_f32 v40, v40
  v_exp_f32 v41, v41
  v_exp_f32 v42, v42
  v_exp_f32 v43, v43
  v_exp_f32 v44, v44
  v_exp_f32 v45, v45
  v_exp_f32 v46, v46
  v_exp_f32 v47, v47
  s_nop 0
  v_cvt_pk_bf16_f32 v64, v32, v33
  v_cvt_pk_bf16_f32 v65, v34, v35
  v_cvt_pk_bf16_f32 v66, v36, v37
  v_cvt_pk_bf16_f32 v67, v38, v39
  v_cvt_pk_bf16_f32 v68, v40, v41
  v_cvt_pk_bf16_f32 v69, v42, v43
  v_cvt_pk_bf16_f32 v70, v44, v45
  v_cvt_pk_bf16_f32 v71, v46, v47
  s_nop 1
  v_mfma_f32_32x32x16_bf16 v[16:31], v[80:83], v[64:67], v[16:31]
  v_mfma_f32_32x32x16_bf16 v[16:31], v[84:87], v[68:71], v[16:31]
  s_add_u32 s82, s82, 1
  s_cmp_lt_u32 s82, 64
  s_cbranch_scc1 L_fb_sum
  s_mov_b32 s34, 1
  s_nop 7
  s_nop 3
  s_branch L_at_norm
L_finish:
  s_cmp_lg_u32 s2, 0
  s_cbranch_scc1 L_exit
  s_cmp_lg_u32 s65, 0
  s_cbranch_scc1 L_exit
  v_mov_b32 v2, s66
  v_mov_b32 v3, 0
  s_mov_b64 exec, 1
  buffer_store_dword v2, v3, s[44:47], 0 offen sc1
L_exit:
  s_endpgm
L_code_end:
  s_endpgm
.section .rodata,"a"
.p2align 6
.amdhsa_kernel concat_heads__softmax_full_mha__ssm_conv_s4d__prompt_kernel
  .amdhsa_next_free_vgpr 128
  .amdhsa_next_free_sgpr 102
  .amdhsa_accum_offset 128
  .amdhsa_group_segment_fixed_size 0
  .amdhsa_kernarg_size 104
  .amdhsa_user_sgpr_count 2
  .amdhsa_user_sgpr_kernarg_segment_ptr 1
  .amdhsa_system_sgpr_workgroup_id_x 1
  .amdhsa_float_denorm_mode_32 3
.end_amdhsa_kernel
```
